```python
import torch

def _softmax(x, axis=-1):
    return torch.softmax(x, dim=axis)
def _gelu(x):
    return torch.nn.functional.gelu(x, approximate="tanh")
def _silu(x):
    return torch.nn.functional.silu(x)
def _sigmoid(x):
    return torch.sigmoid(x)
def _layernorm(x, axis=-1, eps=1e-5):
    m = x.mean(dim=axis, keepdim=True)
    v = x.var(dim=axis, keepdim=True, unbiased=False)
    return (x - m) / torch.sqrt(v + eps)
def _scatter_add(tgt, idx, src, axis=0):
    return tgt.clone().index_add_(axis, idx, src)
def _segment_sum(src, seg, n):
    out = torch.zeros((n,) + src.shape[1:], dtype=src.dtype)
    return out.index_add_(0, seg, src)
def _pad(x, pw):
    flat = tuple(v for pair in reversed(pw) for v in pair)
    return torch.nn.functional.pad(x, flat)

kernel_name = 'parallel_sum__ssm_conv_s4d__glu_gated_bilinear__prompt'

def setup_inputs():

    _w = (lambda a: (lambda t: t.to(torch.bfloat16) if t.is_floating_point() else t)(torch.as_tensor(a)))
    def _A_setup():
        Bsz, L, D, N = 1, 2048, 512, 128
        return {
            "u": _w((lambda *s: torch.randn(*s, dtype=torch.bfloat16) * 0.05)(Bsz, L, D)),
            "log_A_real": _w((lambda *s: torch.randn(*s, dtype=torch.bfloat16) * 6.4)(D, N) * 0.5),
            "A_imag": _w((lambda *s: torch.randn(*s, dtype=torch.bfloat16) * 0.05)(D, N) * 3.14),
            "C_real": _w((lambda *s: torch.randn(*s, dtype=torch.bfloat16) * 0.05)(D, N) / N ** 0.5),
            "C_imag": _w((lambda *s: torch.randn(*s, dtype=torch.bfloat16) * 0.05)(D, N) / N ** 0.5),
            "log_dt": _w((lambda *s: torch.randn(*s, dtype=torch.bfloat16) * 0.05)(D) * 0.5 - 4.0),
            "D_skip": _w((lambda *s: torch.randn(*s, dtype=torch.bfloat16) * 0.05)(D)),
        }
    _A_in = _A_setup()

    def _B_setup():
        B, S, D, F = 1, 2048, 512, 1792
        return {
            "x": _w((lambda *s: torch.randn(*s, dtype=torch.bfloat16) * 0.05)(B, S, D)),
            "w_gate": _w((lambda *s: torch.randn(*s, dtype=torch.bfloat16) * 0.4)(D, F) * (D ** -0.5)),
            "w_up": _w((lambda *s: torch.randn(*s, dtype=torch.bfloat16) * 0.4)(D, F) * (D ** -0.5)),
            "w_down": _w((lambda *s: torch.randn(*s, dtype=torch.bfloat16) * 0.4)(F, D) * (F ** -0.5)),
        }
    _B_in = _B_setup()

    return {
        "A_u": _A_in["u"],
        "A_log_A_real": _A_in["log_A_real"],
        "A_A_imag": _A_in["A_imag"],
        "A_C_real": _A_in["C_real"],
        "A_C_imag": _A_in["C_imag"],
        "A_log_dt": _A_in["log_dt"],
        "A_D_skip": _A_in["D_skip"],
        "B_x": _B_in["x"],
        "B_w_gate": _B_in["w_gate"],
        "B_w_up": _B_in["w_up"],
        "B_w_down": _B_in["w_down"],
    }

def reference(A_u, A_log_A_real, A_A_imag, A_C_real, A_C_imag, A_log_dt, A_D_skip, B_x, B_w_gate, B_w_up, B_w_down):
    def _A_ref(u, log_A_real, A_imag, C_real, C_imag, log_dt, D_skip):
        L = u.shape[1]
        dt = torch.exp(log_dt)
        A = -torch.exp(log_A_real) + 1j * A_imag
        C = (C_real + 1j * C_imag) * dt[:, None]
        pos = (lambda x, dt: x.to(dt))(torch.arange(L), log_dt.dtype)
        P = torch.exp((A * dt[:, None])[:, :, None] * pos[None, None, :])
        K = 2.0 * torch.einsum("dn,dnl->dl", C, P).real
        L2 = 2 * L
        u_t = (lambda x, *d: x.permute(*d))(u, 0, 2, 1)
        Kf = (lambda x, *a, **k: torch.fft.rfft(x.float(), *a, **k))(K, L2)
        Uf = (lambda x, *a, **k: torch.fft.rfft(x.float(), *a, **k))(u_t, L2)
        y = (lambda x, *a, **k: torch.fft.irfft(x, *a, **k).to(torch.bfloat16))(Uf * Kf[None, :, :], L2)[:, :, :L]
        y = (lambda x, *d: x.permute(*d))(y, 0, 2, 1)
        return y + u * D_skip[None, None, :]

    def _B_ref(x, w_gate, w_up, w_down):
        g = torch.einsum("bsd,df->bsf", x, w_gate)
        u = torch.einsum("bsd,df->bsf", x, w_up)
        h = g * u
        return torch.einsum("bsf,fd->bsd", h, w_down)

    x = A_u
    xn = _layernorm(x, axis=-1)
    return x + _A_ref(xn, A_log_A_real, A_A_imag, A_C_real, A_C_imag, A_log_dt, A_D_skip) + _B_ref(xn, B_w_gate, B_w_up, B_w_down)
```

```asm
; @launch grid=(256,1,1) block=(512,1,1) lds=163840
.amdgcn_target "amdgcn-amd-amdhsa--gfx950"
.text
.globl parallel_sum__ssm_conv_s4d__glu_gated_bilinear__prompt_kernel
.p2align 8
.type parallel_sum__ssm_conv_s4d__glu_gated_bilinear__prompt_kernel,@function
parallel_sum__ssm_conv_s4d__glu_gated_bilinear__prompt_kernel:
    s_cmp_ge_u32 s2, 256
    s_cbranch_scc1 F_end
    s_load_dwordx2 s[12:13], s[0:1], 0
    s_load_dwordx2 s[16:17], s[0:1], 64
    s_load_dwordx2 s[20:21], s[0:1], 72
    s_load_dwordx8 s[64:71], s[0:1], 8
    s_load_dwordx4 s[72:75], s[0:1], 40
    v_lshrrev_b32 v2, 6, v0
    v_and_b32 v1, 63, v0
    v_readfirstlane_b32 s4, v2
    s_mov_b32 s14, 0x200000
    s_mov_b32 s15, 0x20000
    s_mov_b32 s18, 0x1c0000
    s_mov_b32 s19, 0x20000
    s_mov_b32 s22, 0x1c0400
    s_mov_b32 s23, 0x20000
    s_and_b32 s56, s4, 3
    s_lshr_b32 s40, s4, 2
    s_cmp_lt_u32 s2, 32
    s_cselect_b32 s41, 1, 0
    s_cmp_lg_u32 s40, s41
    s_cbranch_scc1 F_nopar
    s_waitcnt lgkmcnt(0)
    s_lshl_b32 s40, s2, 2
    s_load_dword s59, s[72:73], s40
    v_lshlrev_b32 v56, 1, v1
    s_lshl_b32 s40, s2, 9
    s_lshl_b32 s41, s56, 7
    s_add_u32 s40, s40, s41
    s_mov_b32 s38, 131072
    s_mov_b32 s39, 0x20000
    s_mov_b32 s36, s64
    s_mov_b32 s37, s65
    buffer_load_ushort v16, v56, s[36:39], s40 offen
    s_mov_b32 s36, s66
    s_mov_b32 s37, s67
    buffer_load_ushort v17, v56, s[36:39], s40 offen
    s_mov_b32 s36, s68
    s_mov_b32 s37, s69
    buffer_load_ushort v18, v56, s[36:39], s40 offen
    s_mov_b32 s36, s70
    s_mov_b32 s37, s71
    buffer_load_ushort v19, v56, s[36:39], s40 offen
F_nopar:
    s_cmp_lt_u32 s2, 32
    s_cbranch_scc1 F_aux
    s_bfe_u32 s60, s2, 0x20001
    s_and_b32 s40, s2, 1
    s_lshl_b32 s40, s40, 1
    s_add_u32 s60, s60, s40
    s_cmp_ge_u32 s60, 5
    s_cselect_b32 s40, 5, 0
    s_sub_u32 s60, s60, s40
    s_bfe_u32 s6, s2, 0x20001
    s_lshl_b32 s6, s6, 2
    s_bfe_u32 s40, s2, 0x20003
    s_add_u32 s6, s6, s40
    s_and_b32 s7, s2, 1
    s_mul_i32 s7, s7, 7
    s_lshr_b32 s40, s2, 5
    s_add_u32 s7, s7, s40
    s_sub_u32 s7, s7, 1
    s_cmp_lt_u32 s4, 4
    s_cbranch_scc1 F_cons
    v_lshrrev_b32 v2, 4, v1
    v_bfe_u32 v3, v1, 1, 3
    s_and_b32 s41, s56, 1
    s_lshl_b32 s41, s41, 2
    v_xor_b32 v3, v3, v2
    v_xor_b32 v3, s41, v3
    v_and_b32 v4, 1, v1
    v_lshl_or_b32 v3, v3, 1, v4
    v_mul_u32_u24 v4, 3584, v2
    v_lshl_add_u32 v8, v3, 4, v4
    v_and_b32 v3, 7, v1
    v_xor_b32 v3, v3, v2
    v_lshrrev_b32 v4, 3, v1
    v_lshlrev_b32 v4, 10, v4
    v_lshl_add_u32 v9, v3, 4, v4
    v_xor_b32 v10, 64, v9
    v_add_u32 v10, 0x1c00, v10
    v_add_u32 v12, 12288, v8
    s_mul_i32 s42, s56, 28672
    s_lshl_b32 s43, s7, 8
    s_add_u32 s42, s42, s43
    s_add_u32 s50, s42, 1835008
    s_mov_b32 s47, s42
    s_lshl_b32 s43, s6, 17
    s_lshl_b32 s44, s56, 14
    s_add_u32 s43, s43, s44
    s_mov_b32 s46, 0
    s_lshl_b32 s44, s56, 12
    s_lshl_b32 s45, s56, 11
    s_add_u32 s45, s45, 98304
    s_waitcnt lgkmcnt(0)
    s_sub_u32 s20, s20, 1024
    s_subb_u32 s21, s21, 0
    s_add_u32 m0, s45, 0
    s_add_u32 s48, s46, s43
    buffer_load_dwordx4 v9, s[12:15], s48 offen lds
    buffer_load_dwordx4 v10, s[12:15], s48 offen offset:1024 lds
    s_add_u32 m0, s44, 0
    s_nop 0
    buffer_load_dwordx4 v8, s[16:19], s47 offen lds
    buffer_load_dwordx4 v8, s[20:23], s47 offen offset:1024 lds
    buffer_load_dwordx4 v12, s[16:19], s47 offen offset:2048 lds
    buffer_load_dwordx4 v12, s[20:23], s47 offen offset:3072 lds
    s_add_u32 m0, s45, 8192
    s_add_u32 s48, s48, 0x10000
    s_add_u32 s46, s46, 128
    buffer_load_dwordx4 v9, s[12:15], s48 offen lds
    buffer_load_dwordx4 v10, s[12:15], s48 offen offset:1024 lds
    s_add_u32 m0, s44, 16384
    s_add_u32 s47, s47, 114688
    buffer_load_dwordx4 v8, s[16:19], s47 offen lds
    buffer_load_dwordx4 v8, s[20:23], s47 offen offset:1024 lds
    buffer_load_dwordx4 v12, s[16:19], s47 offen offset:2048 lds
    buffer_load_dwordx4 v12, s[20:23], s47 offen offset:3072 lds
    s_add_u32 m0, s45, 16384
    s_add_u32 s48, s46, s43
    buffer_load_dwordx4 v9, s[12:15], s48 offen lds
    buffer_load_dwordx4 v10, s[12:15], s48 offen offset:1024 lds
    s_add_u32 m0, s44, 32768
    s_add_u32 s47, s47, 114688
    buffer_load_dwordx4 v8, s[16:19], s47 offen lds
    buffer_load_dwordx4 v8, s[20:23], s47 offen offset:1024 lds
    buffer_load_dwordx4 v12, s[16:19], s47 offen offset:2048 lds
    buffer_load_dwordx4 v12, s[20:23], s47 offen offset:3072 lds
    s_add_u32 m0, s45, 24576
    s_add_u32 s48, s48, 0x10000
    s_add_u32 s46, s46, 128
    buffer_load_dwordx4 v9, s[12:15], s48 offen lds
    buffer_load_dwordx4 v10, s[12:15], s48 offen offset:1024 lds
    s_load_dwordx2 s[8:9], s[0:1], 104
    s_load_dwordx2 s[32:33], s[0:1], 96
    s_load_dwordx2 s[24:25], s[0:1], 80
    s_load_dwordx2 s[28:29], s[0:1], 88
    s_mov_b32 s10, 0x10000000
    s_mov_b32 s11, 0x20000
    s_mov_b32 s34, 0x100
    s_mov_b32 s35, 0x20000
    s_mov_b32 s26, 0x1c0000
    s_mov_b32 s27, 0x20000
    s_mov_b32 s30, 0x200000
    s_mov_b32 s31, 0x20000
    s_and_b32 s53, s2, 7
    s_lshl_b32 s53, s53, 2
    s_lshr_b32 s40, s2, 6
    s_add_u32 s53, s53, s40
    s_bfe_u32 s54, s2, 0x30003
    s_lshl_b32 s40, s2, 2
    s_waitcnt lgkmcnt(0)
    s_load_dword s63, s[74:75], s40
    s_getpc_b64 s[36:37]
F_pc:
    s_sub_u32 s36, s36, F_pc-parallel_sum__ssm_conv_s4d__glu_gated_bilinear__prompt_kernel
    s_subb_u32 s37, s37, 0
    s_bfe_u32 s38, s2, 0x30003
    s_lshl_b32 s38, s38, 2
    s_add_u32 s38, s38, s56
    s_lshl_b32 s38, s38, 10
    s_min_u32 s38, s38, F_last-parallel_sum__ssm_conv_s4d__glu_gated_bilinear__prompt_kernel-1024
    v_lshlrev_b32 v2, 4, v1
    v_add_u32 v2, s38, v2
    global_load_dwordx4 v[240:243], v2, s[36:37]
    s_add_u32 m0, s44, 49152
    s_add_u32 s47, s47, 114688
    buffer_load_dwordx4 v8, s[16:19], s47 offen lds
    v_lshrrev_b32 v2, 4, v1
    v_bfe_u32 v3, v1, 1, 2
    v_xor_b32 v3, v3, v2
    v_and_b32 v4, 1, v1
    v_lshl_or_b32 v3, v3, 1, v4
    v_lshrrev_b32 v4, 3, v1
    v_lshlrev_b32 v4, 10, v4
    v_lshl_add_u32 v11, v3, 4, v4
    s_mul_i32 s86, s56, 458752
    s_lshl_b32 s40, s54, 7
    s_add_u32 s86, s86, s40
    buffer_load_dwordx4 v8, s[20:23], s47 offen offset:1024 lds
    s_add_u32 s87, s86, 458752
    s_mul_i32 s51, s54, 7
    s_lshr_b32 s51, s51, 2
    s_lshl_b32 s51, s51, 15
    s_add_u32 s51, s51, s86
    s_lshl_b32 s52, s56, 12
    v_mov_b32 v6, 163328
    v_mov_b32 v7, 1
    v_and_b32 v14, 31, v1
    v_lshlrev_b32 v14, 2, v14
    s_lshr_b32 s5, s56, 1
    v_and_b32 v58, 15, v1
    buffer_load_dwordx4 v12, s[16:19], s47 offen offset:2048 lds
    v_lshrrev_b32 v59, 4, v1
    v_and_b32 v60, 3, v1
    v_mul_u32_u24 v49, 4160, v60
    v_lshl_add_u32 v49, v59, 4, v49
    v_and_b32 v60, 12, v1
    v_lshlrev_b32 v60, 1, v60
    v_sub_u32 v49, v49, v60
    s_mul_i32 s40, s5, 16640
    s_and_b32 s39, s56, 1
    s_lshl_b32 s39, s39, 8
    s_sub_u32 s40, s40, s39
    s_add_u32 s40, s40, 114976
    buffer_load_dwordx4 v12, s[20:23], s47 offen offset:3072 lds
    v_add_u32 v49, s40, v49
    v_lshlrev_b32 v51, 5, v58
    v_lshl_add_u32 v50, v59, 4, v51
    v_lshl_add_u32 v52, v59, 3, v51
    s_mul_i32 s40, s5, 4608
    s_add_u32 s41, s40, 148448
    v_add_u32 v51, s41, v52
    v_mul_u32_u24 v52, 67584, v59
    v_lshl_add_u32 v52, v58, 3, v52
    s_sub_u32 s40, s40, s39
    s_add_u32 s40, s40, 148224
    s_add_u32 m0, s45, 32768
    s_add_u32 s48, s46, s43
    buffer_load_dwordx4 v9, s[12:15], s48 offen lds
    v_add_u32 v50, s40, v50
    v_and_b32 v54, 255, v0
    v_lshlrev_b32 v58, 3, v54
    v_lshlrev_b32 v54, 4, v54
    v_bfe_u32 v59, v0, 4, 4
    v_and_b32 v55, 0xf0, v54
    v_mul_u32_u24 v53, 65792, v59
    v_add_u32 v55, v55, v53
    v_and_b32 v53, 0x70, v54
    v_lshl_add_u32 v53, v59, 7, v53
    v_bfe_u32 v59, v0, 3, 1
    v_mul_u32_u24 v59, 4608, v59
    buffer_load_dwordx4 v10, s[12:15], s48 offen offset:1024 lds
    v_add_u32 v53, v53, v59
    v_add_u32 v53, 148448, v53
    v_sub_u32 v58, 2051, v58
    s_movk_i32 s41, 128
    s_mov_b32 s40, 155648
    v_subrev_u32 v59, 0, v58
    v_cvt_f32_u32 v60, v59
    v_cvt_pk_bf16_f32 v60, v60, v60
    v_lshrrev_b32 v60, 16, v60
    v_subrev_u32 v60, 0x4280, v60
    v_med3_i32 v60, v60, v59, s41
    v_lshl_add_u32 v38, v60, 1, s40
    s_add_u32 m0, s44, 65536
    s_add_u32 s47, s47, 114688
    buffer_load_dwordx4 v8, s[16:19], s47 offen lds
    v_subrev_u32 v59, 1, v58
    v_cvt_f32_u32 v60, v59
    v_cvt_pk_bf16_f32 v60, v60, v60
    v_lshrrev_b32 v60, 16, v60
    v_subrev_u32 v60, 0x4280, v60
    v_med3_i32 v60, v60, v59, s41
    v_lshl_add_u32 v39, v60, 1, s40
    v_subrev_u32 v59, 2, v58
    v_cvt_f32_u32 v60, v59
    v_cvt_pk_bf16_f32 v60, v60, v60
    v_lshrrev_b32 v60, 16, v60
    buffer_load_dwordx4 v8, s[20:23], s47 offen offset:1024 lds
    v_subrev_u32 v60, 0x4280, v60
    v_med3_i32 v60, v60, v59, s41
    v_lshl_add_u32 v40, v60, 1, s40
    v_subrev_u32 v59, 3, v58
    v_cvt_f32_u32 v60, v59
    v_cvt_pk_bf16_f32 v60, v60, v60
    v_lshrrev_b32 v60, 16, v60
    v_subrev_u32 v60, 0x4280, v60
    v_med3_i32 v60, v60, v59, s41
    v_lshl_add_u32 v41, v60, 1, s40
    v_subrev_u32 v59, 4, v58
    v_cvt_f32_u32 v60, v59
    buffer_load_dwordx4 v12, s[16:19], s47 offen offset:2048 lds
    v_cvt_pk_bf16_f32 v60, v60, v60
    v_lshrrev_b32 v60, 16, v60
    v_subrev_u32 v60, 0x4280, v60
    v_med3_i32 v60, v60, v59, s41
    v_lshl_add_u32 v42, v60, 1, s40
    v_subrev_u32 v59, 5, v58
    v_cvt_f32_u32 v60, v59
    v_cvt_pk_bf16_f32 v60, v60, v60
    v_lshrrev_b32 v60, 16, v60
    v_subrev_u32 v60, 0x4280, v60
    v_med3_i32 v60, v60, v59, s41
    v_lshl_add_u32 v43, v60, 1, s40
    buffer_load_dwordx4 v12, s[20:23], s47 offen offset:3072 lds
    v_subrev_u32 v59, 6, v58
    v_cvt_f32_u32 v60, v59
    v_cvt_pk_bf16_f32 v60, v60, v60
    v_lshrrev_b32 v60, 16, v60
    v_subrev_u32 v60, 0x4280, v60
    v_med3_i32 v60, v60, v59, s41
    v_lshl_add_u32 v44, v60, 1, s40
    v_subrev_u32 v59, 7, v58
    v_cvt_f32_u32 v60, v59
    v_cvt_pk_bf16_f32 v60, v60, v60
    v_lshrrev_b32 v60, 16, v60
    s_add_u32 m0, s45, 40960
    s_add_u32 s48, s48, 0x10000
    s_add_u32 s46, s46, 128
    s_lshl_b32 s3, s60, 7
    s_add_u32 s46, s46, s3
    buffer_load_dwordx4 v9, s[12:15], s48 offen lds
    v_subrev_u32 v60, 0x4280, v60
    v_med3_i32 v60, v60, v59, s41
    v_lshl_add_u32 v45, v60, 1, s40
    v_subrev_u32 v59, 8, v58
    v_cvt_f32_u32 v60, v59
    v_cvt_pk_bf16_f32 v60, v60, v60
    v_lshrrev_b32 v60, 16, v60
    v_subrev_u32 v60, 0x4280, v60
    v_med3_i32 v60, v60, v59, s41
    v_lshl_add_u32 v46, v60, 1, s40
    v_subrev_u32 v59, 9, v58
    v_cvt_f32_u32 v60, v59
    buffer_load_dwordx4 v10, s[12:15], s48 offen offset:1024 lds
    v_cvt_pk_bf16_f32 v60, v60, v60
    v_lshrrev_b32 v60, 16, v60
    v_subrev_u32 v60, 0x4280, v60
    v_med3_i32 v60, v60, v59, s41
    v_lshl_add_u32 v47, v60, 1, s40
    v_subrev_u32 v59, 10, v58
    v_cvt_f32_u32 v60, v59
    v_cvt_pk_bf16_f32 v60, v60, v60
    v_lshrrev_b32 v60, 16, v60
    v_subrev_u32 v60, 0x4280, v60
    v_med3_i32 v60, v60, v59, s41
    v_lshl_add_u32 v48, v60, 1, s40
    s_waitcnt lgkmcnt(0)
    s_lshr_b32 s91, s2, 5
    s_mul_i32 s91, s91, 8448
    s_and_b32 s41, s2, 31
    s_lshl_b32 s41, s41, 1
    s_add_u32 s41, s41, s5
    s_lshl_b32 s41, s41, 7
    s_add_u32 s91, s91, s41
    s_add_u32 s91, s91, 10485760
    s_lshl_b32 s41, s5, 4
    s_lshr_b32 s38, s63, s41
    s_and_b32 s38, s38, 0xffff
    s_and_b32 s41, s56, 1
    s_sub_u32 s41, s41, 1
    s_and_b32 s38, s38, s41
    v_and_b32 v2, 15, v1
    v_lshrrev_b32 v3, 4, v1
    v_lshlrev_b32 v3, 3, v3
    v_sub_u32 v2, v2, v3
    v_add_u32 v2, 16, v2
    v_ashrrev_i32 v2, 1, v2
    v_and_b32 v3, 1, v1
    v_lshlrev_b32 v3, 4, v3
    v_lshlrev_b32 v3, v3, s38
    v_cmp_eq_i32 s[78:79], 0, v2
    v_cmp_eq_i32 s[80:81], 1, v2
    v_cmp_eq_i32 s[82:83], 2, v2
    v_cmp_eq_i32 s[84:85], 3, v2
    v_cndmask_b32 v16, 0, v3, s[78:79]
    v_cndmask_b32 v17, 0, v3, s[80:81]
    v_cndmask_b32 v18, 0, v3, s[82:83]
    v_cndmask_b32 v19, 0, v3, s[84:85]
    s_and_b32 s41, s56, 1
    s_lshl_b32 s41, s41, 5
    s_lshr_b32 s57, s2, 3
    s_add_u32 s57, s57, s41
    s_mul_i32 s57, s57, 1280
    s_and_b32 s41, s2, 7
    s_lshl_b32 s41, s41, 1
    s_add_u32 s41, s41, s5
    s_lshl_b32 s41, s41, 2
    s_add_u32 s57, s57, s41
    s_add_u32 s57, s57, 7471104
    s_bfe_u32 s88, s2, 0x20003
    s_add_u32 s3, s88, 6
    s_min_u32 s3, s3, 15
    s_lshl_b32 s90, s60, 1
    s_add_u32 s89, s3, s90
    s_cmp_ge_u32 s89, 16
    s_cselect_b32 s90, 10, 0
    s_sub_u32 s89, s89, s90
    s_cmp_lt_u32 s3, 6
    s_cselect_b32 s89, s3, s89
    s_mul_i32 s89, s89, 114688
    s_add_u32 s89, s89, s42
    buffer_load_dwordx4 v[224:227], v8, s[16:19], s89 offen offset:0
    buffer_load_dwordx4 v[228:231], v8, s[20:23], s89 offen offset:1024
    buffer_load_dwordx4 v[232:235], v12, s[16:19], s89 offen offset:2048
    buffer_load_dwordx4 v[236:239], v12, s[20:23], s89 offen offset:3072
    s_waitcnt vmcnt(29)
    s_barrier
    s_add_u32 m0, s44, 81920
    s_add_u32 s47, s47, 114688
    buffer_load_dwordx4 v8, s[16:19], s47 offen lds
    buffer_load_dwordx4 v8, s[20:23], s47 offen offset:1024 lds
    buffer_load_dwordx4 v12, s[16:19], s47 offen offset:2048 lds
    buffer_load_dwordx4 v12, s[20:23], s47 offen offset:3072 lds
    s_add_u32 m0, s45, 49152
    s_add_u32 s48, s46, s43
    buffer_load_dwordx4 v9, s[12:15], s48 offen lds
    buffer_load_dwordx4 v10, s[12:15], s48 offen offset:1024 lds
    s_waitcnt vmcnt(29)
    s_barrier
    s_add_u32 m0, s44, 0
    s_add_u32 s47, s47, 114688
    s_mov_b32 s42, s47
    s_mul_i32 s3, s60, 229376
    s_add_u32 s47, s47, s3
    buffer_load_dwordx4 v8, s[16:19], s47 offen lds
    buffer_load_dwordx4 v8, s[20:23], s47 offen offset:1024 lds
    buffer_load_dwordx4 v12, s[16:19], s47 offen offset:2048 lds
    buffer_load_dwordx4 v12, s[20:23], s47 offen offset:3072 lds
    s_waitcnt vmcnt(27)
    s_barrier
    s_add_u32 m0, s45, 0
    s_add_u32 s48, s48, 0x10000
    s_add_u32 s46, s46, 128
    s_cmp_eq_u32 s46, 0x400
    s_cselect_b32 s46, 384, s46
    buffer_load_dwordx4 v9, s[12:15], s48 offen lds
    buffer_load_dwordx4 v10, s[12:15], s48 offen offset:1024 lds
    s_add_u32 m0, s44, 16384
    s_add_u32 s47, s47, 114688
    buffer_load_dwordx4 v8, s[16:19], s47 offen lds
    buffer_load_dwordx4 v8, s[20:23], s47 offen offset:1024 lds
    buffer_load_dwordx4 v12, s[16:19], s47 offen offset:2048 lds
    buffer_load_dwordx4 v12, s[20:23], s47 offen offset:3072 lds
    s_add_u32 m0, s45, 8192
    s_add_u32 s48, s46, s43
    buffer_load_dwordx4 v9, s[12:15], s48 offen lds
    buffer_load_dwordx4 v10, s[12:15], s48 offen offset:1024 lds
    s_waitcnt vmcnt(28)
    s_barrier
    s_add_u32 m0, s44, 32768
    s_add_u32 s47, s47, 114688
    s_cmp_eq_u32 s47, s50
    s_cselect_b32 s47, s42, s47
    buffer_load_dwordx4 v8, s[16:19], s47 offen lds
    buffer_load_dwordx4 v8, s[20:23], s47 offen offset:1024 lds
    buffer_load_dwordx4 v12, s[16:19], s47 offen offset:2048 lds
    buffer_load_dwordx4 v12, s[20:23], s47 offen offset:3072 lds
    s_waitcnt vmcnt(26)
    s_barrier
    s_add_u32 m0, s45, 16384
    s_add_u32 s48, s48, 0x10000
    s_add_u32 s46, s46, 128
    s_cmp_eq_u32 s46, 0x400
    s_cselect_b32 s46, 384, s46
    buffer_load_dwordx4 v9, s[12:15], s48 offen lds
    buffer_load_dwordx4 v10, s[12:15], s48 offen offset:1024 lds
    s_add_u32 m0, s44, 49152
    s_add_u32 s47, s47, 114688
    buffer_load_dwordx4 v8, s[16:19], s47 offen lds
    buffer_load_dwordx4 v8, s[20:23], s47 offen offset:1024 lds
    buffer_load_dwordx4 v12, s[16:19], s47 offen offset:2048 lds
    buffer_load_dwordx4 v12, s[20:23], s47 offen offset:3072 lds
    s_add_u32 m0, s45, 24576
    s_add_u32 s48, s46, s43
    buffer_load_dwordx4 v9, s[12:15], s48 offen lds
    buffer_load_dwordx4 v10, s[12:15], s48 offen offset:1024 lds
    buffer_load_dword v36, v14, s[32:35], 0 offen sc1
    s_waitcnt vmcnt(25)
    s_barrier
    s_add_u32 m0, s44, 65536
    s_add_u32 s47, s47, 114688
    s_cmp_eq_u32 s47, s50
    s_cselect_b32 s47, s42, s47
    buffer_load_dwordx4 v8, s[16:19], s47 offen lds
    buffer_load_dwordx4 v8, s[20:23], s47 offen offset:1024 lds
    buffer_load_dwordx4 v12, s[16:19], s47 offen offset:2048 lds
    buffer_load_dwordx4 v12, s[20:23], s47 offen offset:3072 lds
    s_waitcnt vmcnt(23)
    s_barrier
    s_add_u32 m0, s45, 32768
    s_add_u32 s48, s48, 0x10000
    s_add_u32 s46, s46, 128
    s_cmp_eq_u32 s46, 0x400
    s_cselect_b32 s46, 384, s46
    buffer_load_dwordx4 v9, s[12:15], s48 offen lds
    buffer_load_dwordx4 v10, s[12:15], s48 offen offset:1024 lds
    s_add_u32 m0, s44, 81920
    s_add_u32 s47, s47, 114688
    buffer_load_dwordx4 v8, s[16:19], s47 offen lds
    buffer_load_dwordx4 v8, s[20:23], s47 offen offset:1024 lds
    buffer_load_dwordx4 v12, s[16:19], s47 offen offset:2048 lds
    buffer_load_dwordx4 v12, s[20:23], s47 offen offset:3072 lds
    s_add_u32 m0, s45, 40960
    s_add_u32 s48, s46, s43
    buffer_load_dwordx4 v9, s[12:15], s48 offen lds
    buffer_load_dwordx4 v10, s[12:15], s48 offen offset:1024 lds
    s_waitcnt vmcnt(25)
    s_barrier
    s_add_u32 m0, s44, 0
    s_add_u32 s47, s47, 114688
    s_cmp_eq_u32 s47, s50
    s_cselect_b32 s47, s42, s47
    buffer_load_dwordx4 v8, s[16:19], s47 offen lds
    buffer_load_dwordx4 v8, s[20:23], s47 offen offset:1024 lds
    buffer_load_dwordx4 v12, s[16:19], s47 offen offset:2048 lds
    buffer_load_dwordx4 v12, s[20:23], s47 offen offset:3072 lds
    s_waitcnt vmcnt(23)
    s_barrier
    s_add_u32 m0, s45, 49152
    s_add_u32 s48, s48, 0x10000
    s_add_u32 s46, s46, 128
    s_cmp_eq_u32 s46, 0x400
    s_cselect_b32 s46, 384, s46
    buffer_load_dwordx4 v9, s[12:15], s48 offen lds
    buffer_load_dwordx4 v10, s[12:15], s48 offen offset:1024 lds
    s_add_u32 m0, s44, 16384
    s_add_u32 s47, s47, 114688
    buffer_load_dwordx4 v8, s[16:19], s47 offen lds
    buffer_load_dwordx4 v8, s[20:23], s47 offen offset:1024 lds
    buffer_load_dwordx4 v12, s[16:19], s47 offen offset:2048 lds
    buffer_load_dwordx4 v12, s[20:23], s47 offen offset:3072 lds
    s_add_u32 m0, s45, 0
    s_add_u32 s48, s46, s43
    buffer_load_dwordx4 v9, s[12:15], s48 offen lds
    buffer_load_dwordx4 v10, s[12:15], s48 offen offset:1024 lds
    s_lshr_b32 s88, s2, 3
    s_sub_u32 s88, s88, 4
    s_lshl_b32 s88, s88, 2
    s_add_u32 s88, s88, s56
    s_lshl_b32 s88, s88, 14
    s_and_b32 s89, s2, 1
    s_lshl_b32 s89, s89, 9
    s_add_u32 s88, s88, s89
    s_and_b32 s89, s2, 6
    s_lshl_b32 s89, s89, 11
    v_lshrrev_b32 v229, 5, v1
    v_lshlrev_b32 v229, 10, v229
    v_and_b32 v228, 31, v1
    v_lshl_add_u32 v228, v228, 4, v229
    s_waitcnt vmcnt(25)
    s_barrier
    s_add_u32 m0, s44, 32768
    s_add_u32 s47, s47, 114688
    s_cmp_eq_u32 s47, s50
    s_cselect_b32 s47, s42, s47
    buffer_load_dwordx4 v8, s[16:19], s47 offen lds
    buffer_load_dwordx4 v8, s[20:23], s47 offen offset:1024 lds
    buffer_load_dwordx4 v12, s[16:19], s47 offen offset:2048 lds
    buffer_load_dwordx4 v12, s[20:23], s47 offen offset:3072 lds
    s_add_u32 s90, s88, s89
    buffer_load_dwordx4 v[224:227], v228, s[24:27], s90 offen
    s_add_u32 s89, s89, 0x800
    s_and_b32 s89, s89, 0x3fff
    s_waitcnt vmcnt(23)
    s_barrier
    s_add_u32 m0, s45, 8192
    s_add_u32 s48, s48, 0x10000
    s_add_u32 s46, s46, 128
    s_cmp_eq_u32 s46, 0x400
    s_cselect_b32 s46, 384, s46
    buffer_load_dwordx4 v9, s[12:15], s48 offen lds
    buffer_load_dwordx4 v10, s[12:15], s48 offen offset:1024 lds
    s_add_u32 m0, s44, 49152
    s_add_u32 s47, s47, 114688
    buffer_load_dwordx4 v8, s[16:19], s47 offen lds
    buffer_load_dwordx4 v8, s[20:23], s47 offen offset:1024 lds
    buffer_load_dwordx4 v12, s[16:19], s47 offen offset:2048 lds
    buffer_load_dwordx4 v12, s[20:23], s47 offen offset:3072 lds
    s_add_u32 s90, s88, s89
    buffer_load_dwordx4 v[224:227], v228, s[24:27], s90 offen
    s_add_u32 s89, s89, 0x800
    s_and_b32 s89, s89, 0x3fff
    s_waitcnt vmcnt(24)
    s_barrier
    s_waitcnt vmcnt(36)
    v_cmp_eq_u32 vcc, 0, v36
    s_cbranch_vccz F_tagok_1
    s_mov_b64 exec, -1
    s_mov_b32 s58, 2097152
F_poll_2:
    buffer_load_dword v36, v14, s[32:35], 0 offen sc1
    s_waitcnt vmcnt(0)
    v_cmp_eq_u32 vcc, 0, v36
    s_cbranch_vccz F_polld_3
    s_sleep 3
    s_sub_u32 s58, s58, 1
    s_cmp_lg_u32 s58, 0
    s_cbranch_scc1 F_poll_2
F_polld_3:
    s_mov_b64 exec, -1
F_tagok_1:
    v_readfirstlane_b32 s62, v36
    s_nop 1
    v_mov_b32 v2, s62
    ds_write_b32 v6, v2 offset:8
    s_add_u32 m0, s52, 65536
    s_add_u32 s49, s51, 0
    buffer_load_dwordx4 v11, s[24:27], s49 offen lds
    s_add_u32 m0, s52, 66560
    s_add_u32 s49, s51, 8192
    buffer_load_dwordx4 v11, s[24:27], s49 offen lds
    s_add_u32 m0, s52, 67584
    s_add_u32 s49, s51, 16384
    buffer_load_dwordx4 v11, s[24:27], s49 offen lds
    s_add_u32 m0, s52, 68608
    s_add_u32 s49, s51, 24576
    buffer_load_dwordx4 v11, s[24:27], s49 offen lds
    s_add_u32 s90, s88, s89
    buffer_load_dwordx4 v[224:227], v228, s[24:27], s90 offen
    s_add_u32 s89, s89, 0x800
    s_and_b32 s89, s89, 0x3fff
    s_waitcnt vmcnt(23)
    s_barrier
    s_add_u32 s51, s51, 0x8000
    s_cmp_eq_u32 s51, s87
    s_cselect_b32 s51, s86, s51
    s_add_u32 m0, s52, 81920
    s_add_u32 s49, s51, 0
    buffer_load_dwordx4 v11, s[24:27], s49 offen lds
    s_add_u32 m0, s52, 82944
    s_add_u32 s49, s51, 8192
    buffer_load_dwordx4 v11, s[24:27], s49 offen lds
    s_add_u32 m0, s52, 83968
    s_add_u32 s49, s51, 16384
    buffer_load_dwordx4 v11, s[24:27], s49 offen lds
    s_add_u32 m0, s52, 84992
    s_add_u32 s49, s51, 24576
    buffer_load_dwordx4 v11, s[24:27], s49 offen lds
    s_add_u32 s90, s88, s89
    buffer_load_dwordx4 v[224:227], v228, s[24:27], s90 offen
    s_add_u32 s89, s89, 0x800
    s_and_b32 s89, s89, 0x3fff
    v_lshlrev_b32 v13, 4, v1
    s_lshl_b32 s36, s7, 10
    s_mul_i32 s37, s56, 14336
    s_add_u32 s36, s36, s37
    s_add_u32 s36, s36, 7356416
    s_lshl_b32 s37, s6, 10
    s_add_u32 s37, s37, 7340032
    s_cmp_lt_u32 s56, 2
    s_cselect_b32 s61, s36, s37
    buffer_load_dwordx4 v[196:199], v13, s[8:11], s61 offen sc1
    s_waitcnt vmcnt(23)
    s_barrier
    s_add_u32 s51, s51, 0x8000
    s_cmp_eq_u32 s51, s87
    s_cselect_b32 s51, s86, s51
    s_add_u32 m0, s52, 0
    s_add_u32 s49, s51, 0
    buffer_load_dwordx4 v11, s[24:27], s49 offen lds
    s_add_u32 m0, s52, 1024
    s_add_u32 s49, s51, 8192
    buffer_load_dwordx4 v11, s[24:27], s49 offen lds
    s_add_u32 m0, s52, 2048
    s_add_u32 s49, s51, 16384
    buffer_load_dwordx4 v11, s[24:27], s49 offen lds
    s_add_u32 m0, s52, 3072
    s_add_u32 s49, s51, 24576
    buffer_load_dwordx4 v11, s[24:27], s49 offen lds
    s_add_u32 s90, s88, s89
    buffer_load_dwordx4 v[224:227], v228, s[24:27], s90 offen
    s_add_u32 s89, s89, 0x800
    s_and_b32 s89, s89, 0x3fff
    s_waitcnt vmcnt(21)
    s_barrier
    s_add_u32 s51, s51, 0x8000
    s_cmp_eq_u32 s51, s87
    s_cselect_b32 s51, s86, s51
    s_add_u32 m0, s52, 16384
    s_add_u32 s49, s51, 0
    buffer_load_dwordx4 v11, s[24:27], s49 offen lds
    s_add_u32 m0, s52, 17408
    s_add_u32 s49, s51, 8192
    buffer_load_dwordx4 v11, s[24:27], s49 offen lds
    s_add_u32 m0, s52, 18432
    s_add_u32 s49, s51, 16384
    buffer_load_dwordx4 v11, s[24:27], s49 offen lds
    s_add_u32 m0, s52, 19456
    s_add_u32 s49, s51, 24576
    buffer_load_dwordx4 v11, s[24:27], s49 offen lds
    s_add_u32 s90, s88, s89
    buffer_load_dwordx4 v[224:227], v228, s[24:27], s90 offen
    s_add_u32 s89, s89, 0x800
    s_and_b32 s89, s89, 0x3fff
    s_lshr_b32 s36, s2, 6
    s_lshl_b32 s36, s36, 7
    s_add_u32 s36, s36, 7393280
    buffer_load_dword v37, v14, s[8:11], s36 offen sc1
    s_waitcnt vmcnt(23)
    s_barrier
    s_add_u32 s90, s88, s89
    buffer_load_dwordx4 v[224:227], v228, s[24:27], s90 offen
    s_add_u32 s89, s89, 0x800
    s_and_b32 s89, s89, 0x3fff
    s_cmp_ge_u32 s7, 7
    s_cselect_b32 s37, 13, 0
    s_mul_i32 s36, s56, 7
    s_add_u32 s36, s36, s7
    s_lshl_b32 s36, s36, 1
    s_sub_u32 s36, s36, s37
    s_lshl_b32 s37, s6, 1
    s_cmp_lt_u32 s56, 2
    s_cselect_b32 s36, s36, s37
    s_cselect_b32 s37, 0, 1
    s_add_u32 s37, s37, s36
    v_readlane_b32 s36, v36, s36
    v_readlane_b32 s37, v36, s37
    v_cmp_gt_u32 vcc, 32, v1
    v_mov_b32 v5, s36
    v_mov_b32 v4, s37
    v_cndmask_b32 v4, v4, v5, vcc
    s_mov_b32 s58, 2097152
    s_waitcnt vmcnt(12)
F_grre_4:
    v_cmp_ne_u32 vcc, v4, v197
    v_cmp_ne_u32 s[36:37], v4, v199
    s_or_b64 vcc, vcc, s[36:37]
    s_cbranch_scc0 F_grok_5
    buffer_load_dwordx4 v[196:199], v13, s[8:11], s61 offen sc1
    s_waitcnt vmcnt(0)
    s_sub_u32 s58, s58, 1
    s_cmp_lg_u32 s58, 0
    s_cbranch_scc1 F_grre_4
F_grok_5:
    s_cmp_lt_u32 s56, 2
    s_cbranch_scc0 F_gst_6
    s_lshl_b32 s36, s56, 9
    s_add_u32 s36, s36, 161792
    v_lshl_add_u32 v4, v1, 3, s36
    ds_write2_b32 v4, v196, v198 offset0:0 offset1:1
    s_branch F_gdn_7
F_gst_6:
    v_lshlrev_b32 v196, 16, v196
    v_lshlrev_b32 v198, 16, v198
    v_xor_b32 v196, 0x80000000, v196
    v_xor_b32 v198, 0x80000000, v198
    v_and_b32 v4, 7, v1
    v_lshlrev_b32 v4, 5, v4
    v_bfe_u32 v5, v1, 3, 2
    v_lshl_add_u32 v4, v5, 2, v4
    v_lshrrev_b32 v5, 5, v1
    v_lshl_add_u32 v4, v5, 8, v4
    v_add_u32 v4, 162816, v4
    ds_write2_b32 v4, v196, v198 offset0:0 offset1:4
F_gdn_7:
    s_waitcnt lgkmcnt(0)
    s_barrier
    s_waitcnt vmcnt(1)
    v_cmp_ne_u32 vcc, v36, v37
    s_cmp_eq_u64 vcc, 0
    s_cselect_b32 s55, 2, 0
    s_cbranch_scc0 F_nou_8
    s_lshl_b32 s36, s2, 8
    s_add_u32 s36, s36, 7864320
    s_add_u32 s37, s36, 1052672
    buffer_load_dwordx4 v[188:191], v55, s[8:11], s36 offen sc1
    buffer_load_dwordx4 v[192:195], v55, s[8:11], s37 offen sc1
F_nou_8:
    s_cmp_eq_u32 s55, 2
    s_cbranch_scc1 F_nox2_9
    s_lshr_b32 s36, s2, 6
    s_lshl_b32 s36, s36, 7
    s_add_u32 s36, s36, 7393280
    buffer_load_dword v37, v14, s[8:11], s36 offen sc1
F_nox2_9:
    s_add_u32 s90, s88, s89
    buffer_load_dwordx4 v[224:227], v228, s[24:27], s90 offen
    s_add_u32 s89, s89, 0x800
    s_and_b32 s89, s89, 0x3fff
    ds_read_u16 v56, v38 offset:0
    ds_read_u16 v57, v39 offset:0
    ds_read_u16 v58, v40 offset:0
    ds_read_u16 v59, v41 offset:0
    ds_read_u16 v60, v42 offset:0
    ds_read_u16 v61, v43 offset:0
    ds_read_u16 v62, v44 offset:0
    ds_read_u16 v63, v45 offset:0
    ds_read_u16 v64, v46 offset:0
    ds_read_u16 v65, v47 offset:0
    ds_read_u16 v66, v48 offset:0
    ds_read_u16 v67, v38 offset:3072
    ds_read_u16 v68, v39 offset:3072
    ds_read_u16 v69, v40 offset:3072
    ds_read_u16 v70, v41 offset:3072
    ds_read_u16 v71, v42 offset:3072
    ds_read_u16 v72, v43 offset:3072
    ds_read_u16 v73, v44 offset:3072
    ds_read_u16 v74, v45 offset:3072
    ds_read_u16 v75, v46 offset:3072
    ds_read_u16 v76, v47 offset:3072
    ds_read_u16 v77, v48 offset:3072
    s_waitcnt lgkmcnt(0)
    v_lshl_or_b32 v128, v60, 16, v59
    v_lshl_or_b32 v129, v62, 16, v61
    v_lshl_or_b32 v130, v64, 16, v63
    v_lshl_or_b32 v131, v66, 16, v65
    v_lshl_or_b32 v132, v59, 16, v58
    v_lshl_or_b32 v133, v61, 16, v60
    v_lshl_or_b32 v134, v63, 16, v62
    v_lshl_or_b32 v135, v65, 16, v64
    v_lshl_or_b32 v136, v58, 16, v57
    v_lshl_or_b32 v137, v60, 16, v59
    v_lshl_or_b32 v138, v62, 16, v61
    v_lshl_or_b32 v139, v64, 16, v63
    v_lshl_or_b32 v140, v57, 16, v56
    v_lshl_or_b32 v141, v59, 16, v58
    v_lshl_or_b32 v142, v61, 16, v60
    v_lshl_or_b32 v143, v63, 16, v62
    v_lshl_or_b32 v144, v71, 16, v70
    v_lshl_or_b32 v145, v73, 16, v72
    v_lshl_or_b32 v146, v75, 16, v74
    v_lshl_or_b32 v147, v77, 16, v76
    v_lshl_or_b32 v148, v70, 16, v69
    v_lshl_or_b32 v149, v72, 16, v71
    v_lshl_or_b32 v150, v74, 16, v73
    v_lshl_or_b32 v151, v76, 16, v75
    v_lshl_or_b32 v152, v69, 16, v68
    v_lshl_or_b32 v153, v71, 16, v70
    v_lshl_or_b32 v154, v73, 16, v72
    v_lshl_or_b32 v155, v75, 16, v74
    v_lshl_or_b32 v156, v68, 16, v67
    v_lshl_or_b32 v157, v70, 16, v69
    v_lshl_or_b32 v158, v72, 16, v71
    v_lshl_or_b32 v159, v74, 16, v73
    v_add_u32 v78, 114688, v54
    s_lshl_b32 s41, s56, 2
    v_add_u32 v3, s41, v6
    s_waitcnt vmcnt(4)
    s_mov_b64 exec, 1
    ds_write_b32 v3, v7 offset:32
    s_mov_b64 exec, -1
    s_cmp_eq_u32 s55, 2
    s_cbranch_scc1 F_nou2_10
    s_waitcnt vmcnt(0)
    v_cmp_ne_u32 vcc, v36, v37
    s_cmp_eq_u64 vcc, 0
    s_cselect_b32 s55, 2, 0
    s_cbranch_scc0 F_nou2_10
    s_lshl_b32 s36, s2, 8
    s_add_u32 s36, s36, 7864320
    s_add_u32 s37, s36, 1052672
    buffer_load_dwordx4 v[188:191], v55, s[8:11], s36 offen sc1
    buffer_load_dwordx4 v[192:195], v55, s[8:11], s37 offen sc1
F_nou2_10:
    v_lshrrev_b32 v80, 3, v1
    v_and_b32 v81, 3, v80
    v_and_b32 v82, 7, v1
    v_lshlrev_b32 v82, 1, v82
    v_sub_u32 v83, v81, v82
    v_lshrrev_b32 v84, 5, v1
    v_mul_u32_u24 v84, 3072, v84
    v_max_i32 v85, 1, v83
    v_lshl_add_u32 v84, v85, 1, v84
    v_add_u32 v84, 155646, v84
    ds_read_u16 v86, v84 offset:2
    ds_read_u16 v87, v84
    v_mul_u32_u24 v80, 4160, v80
    v_lshl_add_u32 v80, v82, 1, v80
    v_add_u32 v161, 118784, v80
    v_cmp_eq_u32 vcc, 0, v83
    v_cmp_lt_i32 s[40:41], 0, v83
    s_waitcnt lgkmcnt(0)
    v_lshl_or_b32 v86, v87, 16, v86
    v_cndmask_b32 v87, 0, v87, vcc
    v_cndmask_b32 v160, v87, v86, s[40:41]
    v_mov_b64 v[164:165], 0
    v_mov_b64 v[166:167], 0
    v_lshrrev_b32 v84, 5, v1
    v_mul_u32_u24 v84, 4608, v84
    v_and_b32 v85, 31, v1
    v_min_u32 v85, 29, v85
    v_lshl_add_u32 v84, v85, 4, v84
    v_add_u32 v162, 147968, v84
    s_mov_b64 exec, 1
    ds_add_u32 v6, v7 offset:28
    s_mov_b64 exec, -1
    ds_write_b128 v78, v[128:131] offset:0
    ds_write_b128 v78, v[132:135] offset:4160
    ds_write_b128 v78, v[136:139] offset:8320
    ds_write_b128 v78, v[140:143] offset:12480
    ds_write_b128 v78, v[144:147] offset:16640
    ds_write_b128 v78, v[148:151] offset:20800
    ds_write_b128 v78, v[152:155] offset:24960
    ds_write_b128 v78, v[156:159] offset:29120
    s_mov_b32 s58, 2097152
F_lw_11:
    ds_read_b32 v2, v6 offset:28
    s_waitcnt lgkmcnt(0)
    v_readfirstlane_b32 s40, v2
    s_cmp_ge_u32 s40, 4
    s_cbranch_scc1 F_lwd_12
    s_sleep 1
    s_sub_u32 s58, s58, 1
    s_cmp_lg_u32 s58, 0
    s_cbranch_scc1 F_lw_11
F_lwd_12:
    s_waitcnt vmcnt(0)
F_pp:
    s_cmp_lg_u32 s56, 0
    s_cbranch_scc1 F_t1_14
    ds_write_b32 v161, v160
    ds_write_b128 v162, v[164:167]
F_t1_14:
    s_waitcnt vmcnt(28)
    s_cmp_eq_u32 s55, 2
    s_cbranch_scc1 F_uj_15
    s_cmp_eq_u32 s55, 1
    s_cbranch_scc1 F_uok_13
    s_lshr_b32 s41, s2, 6
    s_lshl_b32 s41, s41, 7
    s_add_u32 s41, s41, 7393280
    s_mov_b64 exec, -1
    s_mov_b32 s58, 2097152
F_poll_16:
    buffer_load_dword v37, v14, s[8:11], s41 offen sc1
    s_waitcnt vmcnt(0)
    v_cmp_ne_u32 vcc, v36, v37
    s_cbranch_vccz F_polld_17
    s_sleep 3
    s_sub_u32 s58, s58, 1
    s_cmp_lg_u32 s58, 0
    s_cbranch_scc1 F_poll_16
F_polld_17:
    s_mov_b64 exec, -1
    s_lshl_b32 s36, s2, 8
    s_add_u32 s36, s36, 7864320
    s_add_u32 s37, s36, 1052672
    buffer_load_dwordx4 v[188:191], v55, s[8:11], s36 offen sc1
    buffer_load_dwordx4 v[192:195], v55, s[8:11], s37 offen sc1
F_uok_13:
    s_waitcnt vmcnt(0)
F_uj_15:
    ds_write_b128 v53, v[188:191]
    ds_write_b128 v53, v[192:195] offset:2048
    s_mov_b64 exec, 1
    ds_add_u32 v6, v7 offset:0
    s_mov_b64 exec, -1
    s_mov_b32 s58, 2097152
F_lw_18:
    ds_read_b32 v2, v6 offset:0
    s_waitcnt lgkmcnt(0)
    v_readfirstlane_b32 s40, v2
    s_cmp_ge_u32 s40, 4
    s_cbranch_scc1 F_lwd_19
    s_sleep 1
    s_sub_u32 s58, s58, 1
    s_cmp_lg_u32 s58, 0
    s_cbranch_scc1 F_lw_18
F_lwd_19:
    s_setprio 1
    ds_read_b64 v[88:89], v49 offset:3776
    ds_read_b64 v[90:91], v49 offset:3784
    ds_read_b128 v[92:95], v50 offset:192
    ds_read_b128 v[96:99], v50 offset:704
    ds_read_b128 v[100:103], v50 offset:1216
    ds_read_b128 v[104:107], v50 offset:1728
    ds_read_b128 v[108:111], v50 offset:2240
    ds_read_b128 v[112:115], v50 offset:2752
    ds_read_b128 v[116:119], v50 offset:3264
    ds_read_b128 v[120:123], v50 offset:3776
    ds_read_b64 v[124:125], v49 offset:3264
    ds_read_b64 v[126:127], v49 offset:3272
    ds_read_b64 v[128:129], v49 offset:2752
    ds_read_b64 v[130:131], v49 offset:2760
    s_waitcnt lgkmcnt(11)
    v_mfma_f32_16x16x32_bf16 v[56:59], v[92:95], v[88:91], 0
    ds_read_b64 v[132:133], v49 offset:2240
    ds_read_b64 v[134:135], v49 offset:2248
    s_waitcnt lgkmcnt(12)
    v_mfma_f32_16x16x32_bf16 v[60:63], v[96:99], v[88:91], 0
    ds_read_b64 v[136:137], v49 offset:1728
    ds_read_b64 v[138:139], v49 offset:1736
    s_waitcnt lgkmcnt(13)
    v_mfma_f32_16x16x32_bf16 v[64:67], v[100:103], v[88:91], 0
    ds_read_b64 v[140:141], v49 offset:1216
    ds_read_b64 v[142:143], v49 offset:1224
    s_waitcnt lgkmcnt(14)
    v_mfma_f32_16x16x32_bf16 v[68:71], v[104:107], v[88:91], 0
    ds_read_b64 v[144:145], v49 offset:704
    ds_read_b64 v[146:147], v49 offset:712
    s_waitcnt lgkmcnt(15)
    v_mfma_f32_16x16x32_bf16 v[72:75], v[108:111], v[88:91], 0
    ds_read_b64 v[148:149], v49 offset:192
    ds_read_b64 v[150:151], v49 offset:200
    s_waitcnt lgkmcnt(15)
    v_mfma_f32_16x16x32_bf16 v[76:79], v[112:115], v[88:91], 0
    ds_read_b64 v[152:153], v49 offset:3712
    ds_read_b64 v[154:155], v49 offset:3720
    v_mfma_f32_16x16x32_bf16 v[80:83], v[116:119], v[88:91], 0
    ds_read_b128 v[156:159], v50 offset:128
    ds_read_b128 v[160:163], v50 offset:640
    s_waitcnt lgkmcnt(15)
    v_mfma_f32_16x16x32_bf16 v[84:87], v[120:123], v[88:91], 0
    ds_read_b128 v[164:167], v50 offset:1152
    ds_read_b128 v[168:171], v50 offset:1664
    v_mfma_f32_16x16x32_bf16 v[56:59], v[92:95], v[16:19], v[56:59]
    ds_read_b128 v[172:175], v50 offset:2176
    ds_read_b128 v[176:179], v50 offset:2688
    v_mfma_f32_16x16x32_bf16 v[60:63], v[96:99], v[16:19], v[60:63]
    ds_read_b128 v[180:183], v50 offset:3200
    ds_read_b128 v[184:187], v50 offset:3712
    v_mfma_f32_16x16x32_bf16 v[64:67], v[100:103], v[16:19], v[64:67]
    ds_read_b64 v[188:189], v49 offset:3200
    ds_read_b64 v[190:191], v49 offset:3208
    v_mfma_f32_16x16x32_bf16 v[68:71], v[104:107], v[16:19], v[68:71]
    ds_read_b64 v[192:193], v49 offset:2688
    ds_read_b64 v[194:195], v49 offset:2696
    v_mfma_f32_16x16x32_bf16 v[72:75], v[108:111], v[16:19], v[72:75]
    ds_read_b64 v[196:197], v49 offset:2176
    ds_read_b64 v[198:199], v49 offset:2184
    v_mfma_f32_16x16x32_bf16 v[76:79], v[112:115], v[16:19], v[76:79]
    ds_read_b64 v[200:201], v49 offset:1664
    ds_read_b64 v[202:203], v49 offset:1672
    v_mfma_f32_16x16x32_bf16 v[80:83], v[116:119], v[16:19], v[80:83]
    ds_read_b64 v[204:205], v49 offset:1152
    ds_read_b64 v[206:207], v49 offset:1160
    v_mfma_f32_16x16x32_bf16 v[84:87], v[120:123], v[16:19], v[84:87]
    ds_read_b64 v[208:209], v49 offset:640
    ds_read_b64 v[210:211], v49 offset:648
    v_mfma_f32_16x16x32_bf16 v[60:63], v[92:95], v[124:127], v[60:63]
    ds_read_b64 v[212:213], v49 offset:128
    ds_read_b64 v[214:215], v49 offset:136
    v_mfma_f32_16x16x32_bf16 v[64:67], v[96:99], v[124:127], v[64:67]
    ds_read_b64 v[88:89], v49 offset:3648
    ds_read_b64 v[90:91], v49 offset:3656
    v_mfma_f32_16x16x32_bf16 v[68:71], v[100:103], v[124:127], v[68:71]
    ds_read_b128 v[120:123], v50 offset:64
    v_mfma_f32_16x16x32_bf16 v[72:75], v[104:107], v[124:127], v[72:75]
    v_mfma_f32_16x16x32_bf16 v[76:79], v[108:111], v[124:127], v[76:79]
    v_mfma_f32_16x16x32_bf16 v[80:83], v[112:115], v[124:127], v[80:83]
    v_mfma_f32_16x16x32_bf16 v[84:87], v[116:119], v[124:127], v[84:87]
    ds_read_b128 v[116:119], v50 offset:576
    ds_read_b128 v[124:127], v50 offset:1088
    s_waitcnt lgkmcnt(15)
    v_mfma_f32_16x16x32_bf16 v[64:67], v[92:95], v[128:131], v[64:67]
    v_mfma_f32_16x16x32_bf16 v[68:71], v[96:99], v[128:131], v[68:71]
    v_mfma_f32_16x16x32_bf16 v[72:75], v[100:103], v[128:131], v[72:75]
    v_mfma_f32_16x16x32_bf16 v[76:79], v[104:107], v[128:131], v[76:79]
    v_mfma_f32_16x16x32_bf16 v[80:83], v[108:111], v[128:131], v[80:83]
    v_mfma_f32_16x16x32_bf16 v[84:87], v[112:115], v[128:131], v[84:87]
    ds_read_b128 v[128:131], v50 offset:1600
    ds_read_b128 v[112:115], v50 offset:2112
    v_mfma_f32_16x16x32_bf16 v[68:71], v[92:95], v[132:135], v[68:71]
    v_mfma_f32_16x16x32_bf16 v[72:75], v[96:99], v[132:135], v[72:75]
    v_mfma_f32_16x16x32_bf16 v[76:79], v[100:103], v[132:135], v[76:79]
    v_mfma_f32_16x16x32_bf16 v[80:83], v[104:107], v[132:135], v[80:83]
    v_mfma_f32_16x16x32_bf16 v[84:87], v[108:111], v[132:135], v[84:87]
    ds_read_b128 v[108:111], v50 offset:2624
    ds_read_b128 v[132:135], v50 offset:3136
    v_mfma_f32_16x16x32_bf16 v[72:75], v[92:95], v[136:139], v[72:75]
    v_mfma_f32_16x16x32_bf16 v[76:79], v[96:99], v[136:139], v[76:79]
    v_mfma_f32_16x16x32_bf16 v[80:83], v[100:103], v[136:139], v[80:83]
    v_mfma_f32_16x16x32_bf16 v[84:87], v[104:107], v[136:139], v[84:87]
    ds_read_b128 v[136:139], v50 offset:3648
    ds_read_b64 v[104:105], v49 offset:3136
    ds_read_b64 v[106:107], v49 offset:3144
    v_mfma_f32_16x16x32_bf16 v[76:79], v[92:95], v[140:143], v[76:79]
    v_mfma_f32_16x16x32_bf16 v[80:83], v[96:99], v[140:143], v[80:83]
    v_mfma_f32_16x16x32_bf16 v[84:87], v[100:103], v[140:143], v[84:87]
    ds_read_b64 v[140:141], v49 offset:2624
    ds_read_b64 v[142:143], v49 offset:2632
    v_mfma_f32_16x16x32_bf16 v[80:83], v[92:95], v[144:147], v[80:83]
    ds_read_b64 v[100:101], v49 offset:2112
    ds_read_b64 v[102:103], v49 offset:2120
    v_mfma_f32_16x16x32_bf16 v[84:87], v[96:99], v[144:147], v[84:87]
    ds_read_b64 v[96:97], v49 offset:1600
    ds_read_b64 v[98:99], v49 offset:1608
    v_mfma_f32_16x16x32_bf16 v[84:87], v[92:95], v[148:151], v[84:87]
    ds_read_b64 v[144:145], v49 offset:1088
    ds_read_b64 v[146:147], v49 offset:1096
    v_mfma_f32_16x16x32_bf16 v[56:59], v[156:159], v[152:155], v[56:59]
    ds_read_b64 v[92:93], v49 offset:576
    ds_read_b64 v[94:95], v49 offset:584
    v_mfma_f32_16x16x32_bf16 v[60:63], v[160:163], v[152:155], v[60:63]
    ds_read_b64 v[148:149], v49 offset:64
    ds_read_b64 v[150:151], v49 offset:72
    v_mfma_f32_16x16x32_bf16 v[64:67], v[164:167], v[152:155], v[64:67]
    v_mfma_f32_16x16x32_bf16 v[68:71], v[168:171], v[152:155], v[68:71]
    v_mfma_f32_16x16x32_bf16 v[72:75], v[172:175], v[152:155], v[72:75]
    v_mfma_f32_16x16x32_bf16 v[76:79], v[176:179], v[152:155], v[76:79]
    v_mfma_f32_16x16x32_bf16 v[80:83], v[180:183], v[152:155], v[80:83]
    v_mfma_f32_16x16x32_bf16 v[84:87], v[184:187], v[152:155], v[84:87]
    ds_read_b64 v[184:185], v49 offset:3584
    ds_read_b64 v[186:187], v49 offset:3592
    v_mfma_f32_16x16x32_bf16 v[60:63], v[156:159], v[188:191], v[60:63]
    ds_read_b128 v[152:155], v50 offset:0
    v_mfma_f32_16x16x32_bf16 v[64:67], v[160:163], v[188:191], v[64:67]
    v_mfma_f32_16x16x32_bf16 v[68:71], v[164:167], v[188:191], v[68:71]
    v_mfma_f32_16x16x32_bf16 v[72:75], v[168:171], v[188:191], v[72:75]
    v_mfma_f32_16x16x32_bf16 v[76:79], v[172:175], v[188:191], v[76:79]
    v_mfma_f32_16x16x32_bf16 v[80:83], v[176:179], v[188:191], v[80:83]
    v_mfma_f32_16x16x32_bf16 v[84:87], v[180:183], v[188:191], v[84:87]
    ds_read_b128 v[188:191], v50 offset:512
    ds_read_b128 v[180:183], v50 offset:1024
    v_mfma_f32_16x16x32_bf16 v[64:67], v[156:159], v[192:195], v[64:67]
    v_mfma_f32_16x16x32_bf16 v[68:71], v[160:163], v[192:195], v[68:71]
    v_mfma_f32_16x16x32_bf16 v[72:75], v[164:167], v[192:195], v[72:75]
    v_mfma_f32_16x16x32_bf16 v[76:79], v[168:171], v[192:195], v[76:79]
    v_mfma_f32_16x16x32_bf16 v[80:83], v[172:175], v[192:195], v[80:83]
    v_mfma_f32_16x16x32_bf16 v[84:87], v[176:179], v[192:195], v[84:87]
    ds_read_b128 v[192:195], v50 offset:1536
    ds_read_b128 v[176:179], v50 offset:2048
    s_waitcnt lgkmcnt(15)
    v_mfma_f32_16x16x32_bf16 v[68:71], v[156:159], v[196:199], v[68:71]
    v_mfma_f32_16x16x32_bf16 v[72:75], v[160:163], v[196:199], v[72:75]
    v_mfma_f32_16x16x32_bf16 v[76:79], v[164:167], v[196:199], v[76:79]
    v_mfma_f32_16x16x32_bf16 v[80:83], v[168:171], v[196:199], v[80:83]
    v_mfma_f32_16x16x32_bf16 v[84:87], v[172:175], v[196:199], v[84:87]
    ds_read_b128 v[196:199], v50 offset:2560
    ds_read_b128 v[172:175], v50 offset:3072
    v_mfma_f32_16x16x32_bf16 v[72:75], v[156:159], v[200:203], v[72:75]
    v_mfma_f32_16x16x32_bf16 v[76:79], v[160:163], v[200:203], v[76:79]
    v_mfma_f32_16x16x32_bf16 v[80:83], v[164:167], v[200:203], v[80:83]
    v_mfma_f32_16x16x32_bf16 v[84:87], v[168:171], v[200:203], v[84:87]
    ds_read_b128 v[168:171], v50 offset:3584
    ds_read_b64 v[200:201], v49 offset:3072
    ds_read_b64 v[202:203], v49 offset:3080
    v_mfma_f32_16x16x32_bf16 v[76:79], v[156:159], v[204:207], v[76:79]
    v_mfma_f32_16x16x32_bf16 v[80:83], v[160:163], v[204:207], v[80:83]
    v_mfma_f32_16x16x32_bf16 v[84:87], v[164:167], v[204:207], v[84:87]
    ds_read_b64 v[164:165], v49 offset:2560
    ds_read_b64 v[166:167], v49 offset:2568
    v_mfma_f32_16x16x32_bf16 v[80:83], v[156:159], v[208:211], v[80:83]
    ds_read_b64 v[204:205], v49 offset:2048
    ds_read_b64 v[206:207], v49 offset:2056
    v_mfma_f32_16x16x32_bf16 v[84:87], v[160:163], v[208:211], v[84:87]
    ds_read_b64 v[208:209], v49 offset:1536
    ds_read_b64 v[210:211], v49 offset:1544
    v_mfma_f32_16x16x32_bf16 v[84:87], v[156:159], v[212:215], v[84:87]
    ds_read_b64 v[160:161], v49 offset:1024
    ds_read_b64 v[162:163], v49 offset:1032
    v_mfma_f32_16x16x32_bf16 v[56:59], v[120:123], v[88:91], v[56:59]
    ds_read_b64 v[212:213], v49 offset:512
    ds_read_b64 v[214:215], v49 offset:520
    v_mfma_f32_16x16x32_bf16 v[60:63], v[116:119], v[88:91], v[60:63]
    ds_read_b64 v[156:157], v49 offset:0
    ds_read_b64 v[158:159], v49 offset:8
    v_mfma_f32_16x16x32_bf16 v[64:67], v[124:127], v[88:91], v[64:67]
    v_mfma_f32_16x16x32_bf16 v[68:71], v[128:131], v[88:91], v[68:71]
    v_mfma_f32_16x16x32_bf16 v[72:75], v[112:115], v[88:91], v[72:75]
    v_mfma_f32_16x16x32_bf16 v[76:79], v[108:111], v[88:91], v[76:79]
    v_mfma_f32_16x16x32_bf16 v[80:83], v[132:135], v[88:91], v[80:83]
    v_mfma_f32_16x16x32_bf16 v[84:87], v[136:139], v[88:91], v[84:87]
    v_mfma_f32_16x16x32_bf16 v[60:63], v[120:123], v[104:107], v[60:63]
    v_mfma_f32_16x16x32_bf16 v[64:67], v[116:119], v[104:107], v[64:67]
    v_mfma_f32_16x16x32_bf16 v[68:71], v[124:127], v[104:107], v[68:71]
    v_mfma_f32_16x16x32_bf16 v[72:75], v[128:131], v[104:107], v[72:75]
    v_mfma_f32_16x16x32_bf16 v[76:79], v[112:115], v[104:107], v[76:79]
    v_mfma_f32_16x16x32_bf16 v[80:83], v[108:111], v[104:107], v[80:83]
    v_mfma_f32_16x16x32_bf16 v[84:87], v[132:135], v[104:107], v[84:87]
    v_mfma_f32_16x16x32_bf16 v[64:67], v[120:123], v[140:143], v[64:67]
    v_mfma_f32_16x16x32_bf16 v[68:71], v[116:119], v[140:143], v[68:71]
    v_mfma_f32_16x16x32_bf16 v[72:75], v[124:127], v[140:143], v[72:75]
    v_mfma_f32_16x16x32_bf16 v[76:79], v[128:131], v[140:143], v[76:79]
    v_mfma_f32_16x16x32_bf16 v[80:83], v[112:115], v[140:143], v[80:83]
    v_mfma_f32_16x16x32_bf16 v[84:87], v[108:111], v[140:143], v[84:87]
    v_mfma_f32_16x16x32_bf16 v[68:71], v[120:123], v[100:103], v[68:71]
    v_mfma_f32_16x16x32_bf16 v[72:75], v[116:119], v[100:103], v[72:75]
    v_mfma_f32_16x16x32_bf16 v[76:79], v[124:127], v[100:103], v[76:79]
    v_mfma_f32_16x16x32_bf16 v[80:83], v[128:131], v[100:103], v[80:83]
    v_mfma_f32_16x16x32_bf16 v[84:87], v[112:115], v[100:103], v[84:87]
    s_waitcnt lgkmcnt(15)
    v_mfma_f32_16x16x32_bf16 v[72:75], v[120:123], v[96:99], v[72:75]
    v_mfma_f32_16x16x32_bf16 v[76:79], v[116:119], v[96:99], v[76:79]
    v_mfma_f32_16x16x32_bf16 v[80:83], v[124:127], v[96:99], v[80:83]
    v_mfma_f32_16x16x32_bf16 v[84:87], v[128:131], v[96:99], v[84:87]
    v_mfma_f32_16x16x32_bf16 v[76:79], v[120:123], v[144:147], v[76:79]
    v_mfma_f32_16x16x32_bf16 v[80:83], v[116:119], v[144:147], v[80:83]
    v_mfma_f32_16x16x32_bf16 v[84:87], v[124:127], v[144:147], v[84:87]
    v_mfma_f32_16x16x32_bf16 v[80:83], v[120:123], v[92:95], v[80:83]
    v_mfma_f32_16x16x32_bf16 v[84:87], v[116:119], v[92:95], v[84:87]
    v_mfma_f32_16x16x32_bf16 v[84:87], v[120:123], v[148:151], v[84:87]
    v_mfma_f32_16x16x32_bf16 v[56:59], v[152:155], v[184:187], v[56:59]
    v_mfma_f32_16x16x32_bf16 v[60:63], v[188:191], v[184:187], v[60:63]
    v_mfma_f32_16x16x32_bf16 v[64:67], v[180:183], v[184:187], v[64:67]
    v_mfma_f32_16x16x32_bf16 v[68:71], v[192:195], v[184:187], v[68:71]
    v_mfma_f32_16x16x32_bf16 v[72:75], v[176:179], v[184:187], v[72:75]
    v_mfma_f32_16x16x32_bf16 v[76:79], v[196:199], v[184:187], v[76:79]
    v_mfma_f32_16x16x32_bf16 v[80:83], v[172:175], v[184:187], v[80:83]
    s_waitcnt lgkmcnt(14)
    v_mfma_f32_16x16x32_bf16 v[84:87], v[168:171], v[184:187], v[84:87]
    s_waitcnt lgkmcnt(12)
    v_mfma_f32_16x16x32_bf16 v[60:63], v[152:155], v[200:203], v[60:63]
    v_mfma_f32_16x16x32_bf16 v[64:67], v[188:191], v[200:203], v[64:67]
    v_mfma_f32_16x16x32_bf16 v[68:71], v[180:183], v[200:203], v[68:71]
    v_mfma_f32_16x16x32_bf16 v[72:75], v[192:195], v[200:203], v[72:75]
    v_mfma_f32_16x16x32_bf16 v[76:79], v[176:179], v[200:203], v[76:79]
    v_mfma_f32_16x16x32_bf16 v[80:83], v[196:199], v[200:203], v[80:83]
    v_mfma_f32_16x16x32_bf16 v[84:87], v[172:175], v[200:203], v[84:87]
    s_waitcnt lgkmcnt(10)
    v_mfma_f32_16x16x32_bf16 v[64:67], v[152:155], v[164:167], v[64:67]
    v_mfma_f32_16x16x32_bf16 v[68:71], v[188:191], v[164:167], v[68:71]
    v_mfma_f32_16x16x32_bf16 v[72:75], v[180:183], v[164:167], v[72:75]
    v_mfma_f32_16x16x32_bf16 v[76:79], v[192:195], v[164:167], v[76:79]
    v_mfma_f32_16x16x32_bf16 v[80:83], v[176:179], v[164:167], v[80:83]
    v_mfma_f32_16x16x32_bf16 v[84:87], v[196:199], v[164:167], v[84:87]
    s_waitcnt lgkmcnt(8)
    v_mfma_f32_16x16x32_bf16 v[68:71], v[152:155], v[204:207], v[68:71]
    v_mfma_f32_16x16x32_bf16 v[72:75], v[188:191], v[204:207], v[72:75]
    v_mfma_f32_16x16x32_bf16 v[76:79], v[180:183], v[204:207], v[76:79]
    v_mfma_f32_16x16x32_bf16 v[80:83], v[192:195], v[204:207], v[80:83]
    v_mfma_f32_16x16x32_bf16 v[84:87], v[176:179], v[204:207], v[84:87]
    s_waitcnt lgkmcnt(6)
    v_mfma_f32_16x16x32_bf16 v[72:75], v[152:155], v[208:211], v[72:75]
    v_mfma_f32_16x16x32_bf16 v[76:79], v[188:191], v[208:211], v[76:79]
    v_mfma_f32_16x16x32_bf16 v[80:83], v[180:183], v[208:211], v[80:83]
    v_mfma_f32_16x16x32_bf16 v[84:87], v[192:195], v[208:211], v[84:87]
    s_waitcnt lgkmcnt(4)
    v_mfma_f32_16x16x32_bf16 v[76:79], v[152:155], v[160:163], v[76:79]
    v_mfma_f32_16x16x32_bf16 v[80:83], v[188:191], v[160:163], v[80:83]
    v_mfma_f32_16x16x32_bf16 v[84:87], v[180:183], v[160:163], v[84:87]
    s_waitcnt lgkmcnt(2)
    v_mfma_f32_16x16x32_bf16 v[80:83], v[152:155], v[212:215], v[80:83]
    v_mfma_f32_16x16x32_bf16 v[84:87], v[188:191], v[212:215], v[84:87]
    s_waitcnt lgkmcnt(0)
    v_mfma_f32_16x16x32_bf16 v[84:87], v[152:155], v[156:159], v[84:87]
    s_lshl_b32 s41, s5, 2
    v_add_u32 v3, s41, v6
    s_mov_b64 exec, 1
    ds_add_u32 v3, v7 offset:16
    s_mov_b64 exec, -1
    s_mul_i32 s41, s5, 16640
    s_and_b32 s40, s56, 1
    s_lshl_b32 s44, s40, 12
    s_add_u32 s41, s41, 114688
    s_add_u32 s45, s41, s44
    v_lshl_add_u32 v4, v1, 4, s45
    s_xor_b32 s44, s44, 0x1000
    s_add_u32 s45, s41, s44
    v_lshl_add_u32 v13, v1, 4, s45
    s_mul_i32 s44, s40, 1081344
    s_add_u32 s42, s91, s44
    s_mov_b32 s58, 2097152
F_lw_20:
    ds_read_b32 v2, v3 offset:16
    s_waitcnt lgkmcnt(0)
    v_readfirstlane_b32 s40, v2
    s_cmp_ge_u32 s40, 3
    s_cbranch_scc1 F_lwd_21
    s_sleep 1
    s_sub_u32 s58, s58, 1
    s_cmp_lg_u32 s58, 0
    s_cbranch_scc1 F_lw_20
F_lwd_21:
    s_bitcmp1_b32 s56, 0
    s_cbranch_scc1 F_h1_22
    ds_write_b128 v13, v[72:75] offset:0
    ds_write_b128 v13, v[76:79] offset:1024
    ds_write_b128 v13, v[80:83] offset:2048
    ds_write_b128 v13, v[84:87] offset:3072
    s_branch F_hj_23
F_h1_22:
    ds_write_b128 v13, v[56:59] offset:0
    ds_write_b128 v13, v[60:63] offset:1024
    ds_write_b128 v13, v[64:67] offset:2048
    ds_write_b128 v13, v[68:71] offset:3072
    v_mov_b64 v[56:57], v[72:73]
    v_mov_b64 v[58:59], v[74:75]
    v_mov_b64 v[60:61], v[76:77]
    v_mov_b64 v[62:63], v[78:79]
    v_mov_b64 v[64:65], v[80:81]
    v_mov_b64 v[66:67], v[82:83]
    v_mov_b64 v[68:69], v[84:85]
    v_mov_b64 v[70:71], v[86:87]
F_hj_23:
    s_mov_b64 exec, 1
    ds_add_u32 v3, v7 offset:16
    s_mov_b64 exec, -1
    s_mov_b32 s58, 2097152
F_lw_24:
    ds_read_b32 v2, v3 offset:16
    s_waitcnt lgkmcnt(0)
    v_readfirstlane_b32 s40, v2
    s_cmp_ge_u32 s40, 5
    s_cbranch_scc1 F_lwd_25
    s_sleep 1
    s_sub_u32 s58, s58, 1
    s_cmp_lg_u32 s58, 0
    s_cbranch_scc1 F_lw_24
F_lwd_25:
    ds_read_b128 v[88:91], v4 offset:0
    ds_read_b128 v[92:95], v4 offset:1024
    ds_read_b128 v[96:99], v4 offset:2048
    ds_read_b128 v[100:103], v4 offset:3072
    s_waitcnt lgkmcnt(3)
    v_add_f32 v56, v56, v88
    v_add_f32 v57, v57, v89
    v_add_f32 v58, v58, v90
    v_add_f32 v59, v59, v91
    v_cvt_pk_bf16_f32 v104, v56, v57
    v_cvt_pk_bf16_f32 v105, v58, v59
    s_add_u32 s44, s42, 0
    buffer_store_dwordx2 v[104:105], v52, s[8:11], s44 offen sc1
    s_waitcnt lgkmcnt(2)
    v_add_f32 v60, v60, v92
    v_add_f32 v61, v61, v93
    v_add_f32 v62, v62, v94
    v_add_f32 v63, v63, v95
    v_cvt_pk_bf16_f32 v108, v60, v61
    v_cvt_pk_bf16_f32 v109, v62, v63
    s_add_u32 s44, s42, 270336
    buffer_store_dwordx2 v[108:109], v52, s[8:11], s44 offen sc1
    s_waitcnt lgkmcnt(1)
    v_add_f32 v64, v64, v96
    v_add_f32 v65, v65, v97
    v_add_f32 v66, v66, v98
    v_add_f32 v67, v67, v99
    v_cvt_pk_bf16_f32 v112, v64, v65
    v_cvt_pk_bf16_f32 v113, v66, v67
    s_add_u32 s44, s42, 540672
    buffer_store_dwordx2 v[112:113], v52, s[8:11], s44 offen sc1
    s_waitcnt lgkmcnt(0)
    v_add_f32 v68, v68, v100
    v_add_f32 v69, v69, v101
    v_add_f32 v70, v70, v102
    v_add_f32 v71, v71, v103
    v_cvt_pk_bf16_f32 v116, v68, v69
    v_cvt_pk_bf16_f32 v117, v70, v71
    s_add_u32 s44, s42, 811008
    buffer_store_dwordx2 v[116:117], v52, s[8:11], s44 offen sc1
F_ptail:
    s_mov_b64 exec, 1
    ds_add_u32 v6, v7 offset:0
    s_mov_b64 exec, -1
    v_lshlrev_b32 v12, 4, v1
    v_lshlrev_b32 v13, 2, v1
    s_lshl_b32 s42, s53, 3
    s_add_u32 s42, s42, s54
    s_mul_i32 s42, s42, 8448
    s_lshl_b32 s41, s56, 11
    s_add_u32 s42, s42, s41
    s_add_u32 s42, s42, 10485760
    s_lshr_b32 s46, s53, 4
    s_lshl_b32 s46, s46, 3
    s_add_u32 s46, s46, s54
    s_lshl_b32 s46, s46, 2
    s_add_u32 s46, s46, s56
    s_mul_i32 s46, s46, 1280
    s_add_u32 s46, s46, 7471104
    v_and_b32 v16, 7, v1
    v_mul_u32_u24 v18, 544, v16
    v_lshrrev_b32 v16, 3, v1
    v_lshl_add_u32 v18, v16, 2, v18
    s_lshl_b32 s49, s56, 6
    s_add_u32 s49, s49, 114688
    v_add_u32 v18, s49, v18
    v_mov_b32 v5, s62
    v_mov_b32 v4, 0
    s_waitcnt vmcnt(0)
    s_mov_b64 exec, 1
    buffer_store_dword v5, v4, s[8:11], s57 offen sc1
    s_mov_b64 exec, -1
    s_mov_b32 s58, 2097152
F_lw_26:
    ds_read_b32 v3, v6 offset:0
    s_waitcnt lgkmcnt(0)
    v_readfirstlane_b32 s40, v3
    s_cmp_ge_u32 s40, 8
    s_cbranch_scc1 F_lwd_27
    s_sleep 1
    s_sub_u32 s58, s58, 1
    s_cmp_lg_u32 s58, 0
    s_cbranch_scc1 F_lw_26
F_lwd_27:
    s_mov_b32 s58, 2097152
F_lw_28:
    ds_read_b32 v3, v6 offset:52
    s_waitcnt lgkmcnt(0)
    v_readfirstlane_b32 s40, v3
    s_cmp_ge_u32 s40, 4
    s_cbranch_scc1 F_lwd_29
    s_sleep 4
    s_sub_u32 s58, s58, 1
    s_cmp_lg_u32 s58, 0
    s_cbranch_scc1 F_lw_28
F_lwd_29:
    v_lshrrev_b32 v2, 3, v0
    v_lshlrev_b32 v9, 10, v2
    v_and_b32 v3, 7, v0
    v_lshl_add_u32 v9, v3, 4, v9
    s_lshl_b32 s55, s53, 16
    s_lshl_b32 s50, s54, 7
    s_add_u32 s55, s55, s50
    v_mul_u32_u24 v10, 272, v2
    v_lshl_add_u32 v10, v3, 5, v10
    v_add_u32 v10, 114688, v10
    v_and_b32 v4, 15, v2
    v_lshlrev_b32 v3, 1, v3
    v_xor_b32 v3, v3, v4
    v_lshlrev_b32 v3, 4, v3
    v_lshl_add_u32 v3, v4, 8, v3
    v_lshrrev_b32 v4, 4, v2
    v_lshl_add_u32 v14, v4, 14, v3
    v_xor_b32 v15, 16, v14
    v_lshlrev_b32 v2, 3, v2
    s_lshl_b32 s50, s53, 9
    s_add_u32 s50, s50, 7340032
    buffer_load_dwordx4 v[24:27], v9, s[12:15], s55 offen
    buffer_load_dwordx2 v[28:29], v2, s[8:11], s50 offen sc1
    s_mov_b64 exec, 65535
    s_mov_b32 s58, 2097152
F_poll_30:
    buffer_load_dword v5, v13, s[8:11], s46 offen sc1
    s_waitcnt vmcnt(0)
    v_cmp_ne_u32 vcc, s62, v5
    s_cbranch_vccz F_polld_31
    s_sleep 8
    s_sub_u32 s58, s58, 1
    s_cmp_lg_u32 s58, 0
    s_cbranch_scc1 F_poll_30
F_polld_31:
    s_mov_b64 exec, -1
    buffer_load_dwordx4 v[96:99], v12, s[8:11], s42 offen offset:0 sc1
    buffer_load_dwordx4 v[100:103], v12, s[8:11], s42 offen offset:1024 sc1
    s_waitcnt vmcnt(1)
    v_lshlrev_b32 v112, 16, v96
    v_and_b32 v113, 0xffff0000, v96
    v_lshlrev_b32 v114, 16, v97
    v_and_b32 v115, 0xffff0000, v97
    v_lshlrev_b32 v116, 16, v98
    v_and_b32 v117, 0xffff0000, v98
    v_lshlrev_b32 v118, 16, v99
    v_and_b32 v119, 0xffff0000, v99
    ds_write_b32 v18, v112 offset:0
    ds_write_b32 v18, v113 offset:4352
    ds_write_b32 v18, v114 offset:8704
    ds_write_b32 v18, v115 offset:13056
    ds_write_b32 v18, v116 offset:272
    ds_write_b32 v18, v117 offset:4624
    ds_write_b32 v18, v118 offset:8976
    ds_write_b32 v18, v119 offset:13328
    s_waitcnt vmcnt(0)
    v_lshlrev_b32 v120, 16, v100
    v_and_b32 v121, 0xffff0000, v100
    v_lshlrev_b32 v122, 16, v101
    v_and_b32 v123, 0xffff0000, v101
    v_lshlrev_b32 v124, 16, v102
    v_and_b32 v125, 0xffff0000, v102
    v_lshlrev_b32 v126, 16, v103
    v_and_b32 v127, 0xffff0000, v103
    ds_write_b32 v18, v120 offset:32
    ds_write_b32 v18, v121 offset:4384
    ds_write_b32 v18, v122 offset:8736
    ds_write_b32 v18, v123 offset:13088
    ds_write_b32 v18, v124 offset:304
    ds_write_b32 v18, v125 offset:4656
    ds_write_b32 v18, v126 offset:9008
    ds_write_b32 v18, v127 offset:13360
    v_readlane_b32 s41, v36, s53
    s_mov_b32 s58, 2097152
F_rsr_32:
    s_waitcnt vmcnt(0)
    v_cmp_ne_u32 vcc, s41, v29
    s_cbranch_vccz F_rso_33
    buffer_load_dwordx2 v[28:29], v2, s[8:11], s50 offen sc1
    s_sub_u32 s58, s58, 1
    s_cmp_lg_u32 s58, 0
    s_cbranch_scc1 F_rsr_32
F_rso_33:
    s_branch F_fin
F_cons:
    s_setprio 3
    v_mov_b32 v6, 163328
    v_lshl_add_u32 v2, v1, 2, v6
    v_mov_b32 v3, 0
    ds_write_b32 v2, v3
    s_load_dwordx2 s[8:9], s[0:1], 104
    s_load_dwordx2 s[32:33], s[0:1], 96
    s_load_dwordx2 s[24:25], s[0:1], 80
    s_load_dwordx2 s[28:29], s[0:1], 88
    s_mov_b32 s10, 0x10000000
    s_mov_b32 s11, 0x20000
    s_mov_b32 s34, 0x100
    s_mov_b32 s35, 0x20000
    s_mov_b32 s26, 0x1c0000
    s_mov_b32 s27, 0x20000
    s_mov_b32 s30, 0x200000
    s_mov_b32 s31, 0x20000
    s_and_b32 s53, s2, 7
    s_lshl_b32 s53, s53, 2
    s_lshr_b32 s40, s2, 6
    s_add_u32 s53, s53, s40
    s_bfe_u32 s54, s2, 0x30003
    s_lshl_b32 s40, s2, 2
    s_waitcnt lgkmcnt(0)
    s_load_dword s63, s[74:75], s40
    s_and_b32 s40, s4, 1
    s_lshr_b32 s41, s4, 1
    v_lshrrev_b32 v2, 4, v1
    v_bfe_u32 v3, v1, 2, 2
    v_and_b32 v4, 3, v1
    v_and_b32 v5, 1, v2
    v_lshl_or_b32 v5, v5, 2, v3
    s_lshl_b32 s42, s40, 2
    v_xor_b32 v5, s42, v5
    v_lshlrev_b32 v5, 5, v5
    v_lshl_add_u32 v5, v4, 3, v5
    v_lshl_add_u32 v5, v3, 8, v5
    v_lshl_add_u32 v8, v2, 12, v5
    v_xor_b32 v9, 32, v8
    v_xor_b32 v10, 64, v8
    v_xor_b32 v11, 96, v8
    v_and_b32 v6, 15, v1
    v_lshrrev_b32 v7, 1, v6
    v_xor_b32 v7, v7, v2
    v_lshlrev_b32 v7, 4, v7
    v_lshl_add_u32 v7, v6, 7, v7
    s_lshl_b32 s42, s41, 13
    s_add_u32 s42, s42, 98304
    v_add_u32 v12, s42, v7
    v_xor_b32 v13, 64, v12
    s_lshl_b32 s42, s40, 8
    s_add_u32 s42, s42, 161792
    v_lshl_add_u32 v14, v2, 4, s42
    s_lshl_b32 s42, s41, 8
    s_add_u32 s42, s42, 162816
    v_lshl_add_u32 v44, v6, 4, s42
    v_mov_b32 v15, 0
    s_lshl_b32 s42, s6, 1
    s_add_u32 s42, s42, s41
    s_lshl_b32 s57, s42, 2
    s_mul_i32 s42, s42, 28
    s_lshl_b32 s43, s7, 1
    s_add_u32 s43, s43, s40
    s_add_u32 s42, s42, s43
    s_lshl_b32 s50, s42, 13
    s_add_u32 s51, s50, 4096
    s_mul_i32 s42, s43, 37
    s_lshr_b32 s42, s42, 8
    s_add_u32 s57, s57, s42
    s_mul_i32 s57, s57, 3328
    s_mul_i32 s42, s42, 7
    s_sub_u32 s43, s43, s42
    s_lshl_b32 s43, s43, 2
    s_add_u32 s57, s57, s43
    s_add_u32 s57, s57, 10027008
    s_mov_b64 s[76:77], 1
    s_mov_b32 s44, 0
    s_mov_b32 s45, s41
    s_mov_b32 s52, 16384
    v_mov_b32 v6, 163328
    v_mov_b32 v7, 1
    s_lshl_b32 s40, s56, 12
    s_add_u32 s40, s40, 81920
    v_lshl_add_u32 v20, v1, 2, s40
    v_xor_b32 v21, 16, v20
    v_xor_b32 v22, 32, v20
    v_xor_b32 v23, 48, v20
    v_xor_b32 v24, 64, v20
    v_xor_b32 v25, 80, v20
    v_xor_b32 v26, 96, v20
    v_xor_b32 v27, 112, v20
    v_and_b32 v58, 15, v1
    v_lshrrev_b32 v59, 4, v1
    v_lshrrev_b32 v60, 1, v58
    v_xor_b32 v60, v60, v59
    v_lshlrev_b32 v60, 4, v60
    v_lshl_add_u32 v60, v58, 8, v60
    v_add_u32 v28, s40, v60
    v_xor_b32 v29, 64, v28
    v_xor_b32 v30, 128, v28
    v_xor_b32 v31, 192, v28
    s_lshr_b32 s5, s56, 1
    s_mul_i32 s41, s5, 3072
    s_add_u32 s41, s41, 155648
    v_lshrrev_b32 v60, 1, v59
    v_lshlrev_b32 v60, 8, v60
    v_and_b32 v61, 1, v59
    v_lshl_add_u32 v60, v61, 3, v60
    v_lshl_add_u32 v60, v58, 4, v60
    v_add_u32 v32, s41, v60
    v_cmp_gt_u32 vcc, 2, v59
    v_lshlrev_b32 v60, 7, v59
    v_lshlrev_b32 v61, 2, v58
    v_lshlrev_b32 v62, 3, v58
    v_cndmask_b32 v61, v61, v62, vcc
    v_add3_u32 v33, v60, v61, s41
    v_mov_b32 v61, 64
    v_cndmask_b32 v61, v61, 4, vcc
    v_add_u32 v34, v33, v61
    v_lshl_add_u32 v60, v58, 1, v60
    v_add_u32 v35, s41, v60
    s_waitcnt vmcnt(0) lgkmcnt(0)
    s_lshl_b32 s3, s5, 4
    s_lshr_b32 s3, s59, s3
    s_lshl_b32 s3, s3, 16
    v_mov_b32 v61, 0x3fb8aa3b
    v_mul_f32 v61, s3, v61
    v_lshlrev_b32 v16, 16, v16
    v_lshlrev_b32 v17, 16, v17
    v_lshlrev_b32 v18, 16, v18
    v_lshlrev_b32 v19, 16, v19
    v_mul_f32 v16, 0x3fb8aa3b, v16
    v_exp_f32 v16, v16
    v_exp_f32 v61, v61
    s_nop 0
    v_cvt_pk_bf16_f32 v58, v61, v16
    v_lshlrev_b32 v61, 16, v58
    v_and_b32 v16, 0xffff0000, v58
    v_mul_f32 v56, v16, v61
    v_mul_f32 v57, v17, v61
    v_mul_f32 v56, 0xbfb8aa3b, v56
    v_mul_f32 v57, 0x3e22f983, v57
    v_mul_f32 v62, v18, v61
    v_mul_f32 v63, v19, v61
    v_add_f32 v62, v62, v62
    v_add_f32 v63, v63, v63
    v_mul_f32 v110, 0x41000000, v56
    v_mul_f32 v111, 0x41000000, v57
    v_mul_f32 v112, 0x41800000, v56
    v_mul_f32 v113, 0x41800000, v57
    v_mul_f32 v114, 0x3f800000, v56
    v_mul_f32 v115, 0x3f800000, v57
    v_mul_f32 v116, 0x43000000, v56
    v_mul_f32 v117, 0x43000000, v57
    v_mul_f32 v118, 0x44800000, v56
    v_mul_f32 v119, 0x44800000, v57
    v_fract_f32 v111, v111
    v_exp_f32 v110, v110
    v_fract_f32 v113, v113
    v_exp_f32 v112, v112
    v_fract_f32 v115, v115
    v_exp_f32 v114, v114
    v_fract_f32 v117, v117
    v_exp_f32 v116, v116
    v_fract_f32 v119, v119
    v_exp_f32 v118, v118
    v_cos_f32 v64, v111
    v_sin_f32 v65, v111
    v_cos_f32 v106, v113
    v_sin_f32 v107, v113
    v_cos_f32 v78, v115
    v_sin_f32 v79, v115
    v_cos_f32 v92, v117
    v_sin_f32 v93, v117
    v_cos_f32 v66, v119
    v_sin_f32 v67, v119
    v_mul_f32 v64, v64, v110
    v_mul_f32 v65, v65, v110
    v_mul_f32 v106, v106, v112
    v_mul_f32 v107, v107, v112
    v_mul_f32 v78, v78, v114
    v_mul_f32 v79, v79, v114
    v_mul_f32 v92, v92, v116
    v_mul_f32 v93, v93, v116
    v_mul_f32 v66, v66, v118
    v_mul_f32 v67, v67, v118
    v_pk_mul_f32 v[110:111], v[62:63], v[64:65] op_sel_hi:[1,0]
    v_pk_fma_f32 v[108:109], v[62:63], v[64:65], v[110:111] op_sel:[1,1,0] op_sel_hi:[0,1,1] neg_lo:[1,0,0]
    v_cvt_pk_bf16_f32 v128, v62, -v63
    v_cvt_pk_bf16_f32 v129, v108, -v109
    v_pk_mul_f32 v[110:111], v[62:63], v[106:107] op_sel_hi:[1,0]
    v_pk_mul_f32 v[112:113], v[108:109], v[106:107] op_sel_hi:[1,0]
    v_pk_mul_f32 v[114:115], v[78:79], v[78:79] op_sel_hi:[1,0]
    v_pk_mul_f32 v[116:117], v[92:93], v[92:93] op_sel_hi:[1,0]
    v_pk_fma_f32 v[62:63], v[62:63], v[106:107], v[110:111] op_sel:[1,1,0] op_sel_hi:[0,1,1] neg_lo:[1,0,0]
    v_pk_fma_f32 v[108:109], v[108:109], v[106:107], v[112:113] op_sel:[1,1,0] op_sel_hi:[0,1,1] neg_lo:[1,0,0]
    v_pk_fma_f32 v[80:81], v[78:79], v[78:79], v[114:115] op_sel:[1,1,0] op_sel_hi:[0,1,1] neg_lo:[1,0,0]
    v_pk_fma_f32 v[94:95], v[92:93], v[92:93], v[116:117] op_sel:[1,1,0] op_sel_hi:[0,1,1] neg_lo:[1,0,0]
    ds_write2st64_b32 v20, v128, v129 offset0:0 offset1:1
    v_cvt_pk_bf16_f32 v130, v62, -v63
    v_cvt_pk_bf16_f32 v131, v108, -v109
    v_pk_mul_f32 v[110:111], v[62:63], v[106:107] op_sel_hi:[1,0]
    v_pk_mul_f32 v[112:113], v[108:109], v[106:107] op_sel_hi:[1,0]
    v_pk_mul_f32 v[114:115], v[80:81], v[78:79] op_sel_hi:[1,0]
    v_pk_mul_f32 v[116:117], v[94:95], v[92:93] op_sel_hi:[1,0]
    v_pk_fma_f32 v[62:63], v[62:63], v[106:107], v[110:111] op_sel:[1,1,0] op_sel_hi:[0,1,1] neg_lo:[1,0,0]
    v_pk_fma_f32 v[108:109], v[108:109], v[106:107], v[112:113] op_sel:[1,1,0] op_sel_hi:[0,1,1] neg_lo:[1,0,0]
    v_pk_fma_f32 v[82:83], v[80:81], v[78:79], v[114:115] op_sel:[1,1,0] op_sel_hi:[0,1,1] neg_lo:[1,0,0]
    v_pk_fma_f32 v[96:97], v[94:95], v[92:93], v[116:117] op_sel:[1,1,0] op_sel_hi:[0,1,1] neg_lo:[1,0,0]
    ds_write2st64_b32 v21, v130, v131 offset0:2 offset1:3
    v_cvt_pk_bf16_f32 v132, v62, -v63
    v_cvt_pk_bf16_f32 v133, v108, -v109
    v_pk_mul_f32 v[110:111], v[62:63], v[106:107] op_sel_hi:[1,0]
    v_pk_mul_f32 v[112:113], v[108:109], v[106:107] op_sel_hi:[1,0]
    v_pk_mul_f32 v[114:115], v[82:83], v[78:79] op_sel_hi:[1,0]
    v_pk_mul_f32 v[116:117], v[96:97], v[92:93] op_sel_hi:[1,0]
    v_pk_fma_f32 v[62:63], v[62:63], v[106:107], v[110:111] op_sel:[1,1,0] op_sel_hi:[0,1,1] neg_lo:[1,0,0]
    v_pk_fma_f32 v[108:109], v[108:109], v[106:107], v[112:113] op_sel:[1,1,0] op_sel_hi:[0,1,1] neg_lo:[1,0,0]
    v_pk_fma_f32 v[84:85], v[82:83], v[78:79], v[114:115] op_sel:[1,1,0] op_sel_hi:[0,1,1] neg_lo:[1,0,0]
    v_pk_fma_f32 v[98:99], v[96:97], v[92:93], v[116:117] op_sel:[1,1,0] op_sel_hi:[0,1,1] neg_lo:[1,0,0]
    ds_write2st64_b32 v22, v132, v133 offset0:4 offset1:5
    v_cvt_pk_bf16_f32 v134, v62, -v63
    v_cvt_pk_bf16_f32 v135, v108, -v109
    v_pk_mul_f32 v[110:111], v[62:63], v[106:107] op_sel_hi:[1,0]
    v_pk_mul_f32 v[112:113], v[108:109], v[106:107] op_sel_hi:[1,0]
    v_pk_mul_f32 v[114:115], v[84:85], v[78:79] op_sel_hi:[1,0]
    v_pk_mul_f32 v[116:117], v[98:99], v[92:93] op_sel_hi:[1,0]
    v_pk_fma_f32 v[62:63], v[62:63], v[106:107], v[110:111] op_sel:[1,1,0] op_sel_hi:[0,1,1] neg_lo:[1,0,0]
    v_pk_fma_f32 v[108:109], v[108:109], v[106:107], v[112:113] op_sel:[1,1,0] op_sel_hi:[0,1,1] neg_lo:[1,0,0]
    v_pk_fma_f32 v[86:87], v[84:85], v[78:79], v[114:115] op_sel:[1,1,0] op_sel_hi:[0,1,1] neg_lo:[1,0,0]
    v_pk_fma_f32 v[100:101], v[98:99], v[92:93], v[116:117] op_sel:[1,1,0] op_sel_hi:[0,1,1] neg_lo:[1,0,0]
    ds_write2st64_b32 v23, v134, v135 offset0:6 offset1:7
    v_cvt_pk_bf16_f32 v136, v62, -v63
    v_cvt_pk_bf16_f32 v137, v108, -v109
    v_pk_mul_f32 v[110:111], v[62:63], v[106:107] op_sel_hi:[1,0]
    v_pk_mul_f32 v[112:113], v[108:109], v[106:107] op_sel_hi:[1,0]
    v_pk_mul_f32 v[114:115], v[86:87], v[78:79] op_sel_hi:[1,0]
    v_pk_mul_f32 v[116:117], v[100:101], v[92:93] op_sel_hi:[1,0]
    v_pk_fma_f32 v[62:63], v[62:63], v[106:107], v[110:111] op_sel:[1,1,0] op_sel_hi:[0,1,1] neg_lo:[1,0,0]
    v_pk_fma_f32 v[108:109], v[108:109], v[106:107], v[112:113] op_sel:[1,1,0] op_sel_hi:[0,1,1] neg_lo:[1,0,0]
    v_pk_fma_f32 v[88:89], v[86:87], v[78:79], v[114:115] op_sel:[1,1,0] op_sel_hi:[0,1,1] neg_lo:[1,0,0]
    v_pk_fma_f32 v[102:103], v[100:101], v[92:93], v[116:117] op_sel:[1,1,0] op_sel_hi:[0,1,1] neg_lo:[1,0,0]
    ds_write2st64_b32 v24, v136, v137 offset0:8 offset1:9
    v_cvt_pk_bf16_f32 v138, v62, -v63
    v_cvt_pk_bf16_f32 v139, v108, -v109
    v_pk_mul_f32 v[110:111], v[62:63], v[106:107] op_sel_hi:[1,0]
    v_pk_mul_f32 v[112:113], v[108:109], v[106:107] op_sel_hi:[1,0]
    v_pk_mul_f32 v[114:115], v[88:89], v[78:79] op_sel_hi:[1,0]
    v_pk_mul_f32 v[116:117], v[102:103], v[92:93] op_sel_hi:[1,0]
    v_pk_fma_f32 v[62:63], v[62:63], v[106:107], v[110:111] op_sel:[1,1,0] op_sel_hi:[0,1,1] neg_lo:[1,0,0]
    v_pk_fma_f32 v[108:109], v[108:109], v[106:107], v[112:113] op_sel:[1,1,0] op_sel_hi:[0,1,1] neg_lo:[1,0,0]
    v_pk_fma_f32 v[90:91], v[88:89], v[78:79], v[114:115] op_sel:[1,1,0] op_sel_hi:[0,1,1] neg_lo:[1,0,0]
    v_pk_fma_f32 v[104:105], v[102:103], v[92:93], v[116:117] op_sel:[1,1,0] op_sel_hi:[0,1,1] neg_lo:[1,0,0]
    ds_write2st64_b32 v25, v138, v139 offset0:10 offset1:11
    v_cvt_pk_bf16_f32 v140, v62, -v63
    v_cvt_pk_bf16_f32 v141, v108, -v109
    v_pk_mul_f32 v[110:111], v[62:63], v[106:107] op_sel_hi:[1,0]
    v_pk_mul_f32 v[112:113], v[108:109], v[106:107] op_sel_hi:[1,0]
    v_pk_fma_f32 v[62:63], v[62:63], v[106:107], v[110:111] op_sel:[1,1,0] op_sel_hi:[0,1,1] neg_lo:[1,0,0]
    v_pk_fma_f32 v[108:109], v[108:109], v[106:107], v[112:113] op_sel:[1,1,0] op_sel_hi:[0,1,1] neg_lo:[1,0,0]
    ds_write2st64_b32 v26, v140, v141 offset0:12 offset1:13
    v_cvt_pk_bf16_f32 v142, v62, -v63
    v_cvt_pk_bf16_f32 v143, v108, -v109
    ds_write2st64_b32 v27, v142, v143 offset0:14 offset1:15
    v_mov_b32 v144, 0x3f80
    ds_read_b128 v[192:195], v28
    ds_read_b128 v[196:199], v29
    ds_read_b128 v[200:203], v30
    ds_read_b128 v[204:207], v31
    v_cvt_pk_bf16_f32 v145, v78, v79
    ds_write2st64_b32 v20, v144, v145 offset0:0 offset1:1
    v_cvt_pk_bf16_f32 v146, v80, v81
    v_cvt_pk_bf16_f32 v147, v82, v83
    ds_write2st64_b32 v21, v146, v147 offset0:2 offset1:3
    v_cvt_pk_bf16_f32 v148, v84, v85
    v_cvt_pk_bf16_f32 v149, v86, v87
    ds_write2st64_b32 v22, v148, v149 offset0:4 offset1:5
    v_cvt_pk_bf16_f32 v150, v88, v89
    v_cvt_pk_bf16_f32 v151, v90, v91
    ds_write2st64_b32 v23, v150, v151 offset0:6 offset1:7
    v_cvt_pk_bf16_f32 v152, v92, v93
    v_cvt_pk_bf16_f32 v160, v94, v95
    v_cvt_pk_bf16_f32 v164, v96, v97
    v_cvt_pk_bf16_f32 v176, v66, v67
    v_cvt_pk_bf16_f32 v168, v98, v99
    v_cvt_pk_bf16_f32 v170, v100, v101
    v_cvt_pk_bf16_f32 v172, v102, v103
    v_cvt_pk_bf16_f32 v174, v104, v105
    v_pk_mul_f32 v[110:111], v[92:93], v[78:79] op_sel_hi:[1,0]
    v_pk_mul_f32 v[112:113], v[92:93], v[80:81] op_sel_hi:[1,0]
    v_pk_mul_f32 v[114:115], v[92:93], v[82:83] op_sel_hi:[1,0]
    v_pk_mul_f32 v[116:117], v[92:93], v[84:85] op_sel_hi:[1,0]
    v_pk_fma_f32 v[120:121], v[92:93], v[78:79], v[110:111] op_sel:[1,1,0] op_sel_hi:[0,1,1] neg_lo:[1,0,0]
    v_pk_fma_f32 v[122:123], v[92:93], v[80:81], v[112:113] op_sel:[1,1,0] op_sel_hi:[0,1,1] neg_lo:[1,0,0]
    v_pk_fma_f32 v[124:125], v[92:93], v[82:83], v[114:115] op_sel:[1,1,0] op_sel_hi:[0,1,1] neg_lo:[1,0,0]
    v_pk_fma_f32 v[126:127], v[92:93], v[84:85], v[116:117] op_sel:[1,1,0] op_sel_hi:[0,1,1] neg_lo:[1,0,0]
    v_cvt_pk_bf16_f32 v153, v120, v121
    ds_write2st64_b32 v24, v152, v153 offset0:8 offset1:9
    v_cvt_pk_bf16_f32 v154, v122, v123
    v_cvt_pk_bf16_f32 v155, v124, v125
    ds_write2st64_b32 v25, v154, v155 offset0:10 offset1:11
    v_cvt_pk_bf16_f32 v156, v126, v127
    v_pk_mul_f32 v[110:111], v[92:93], v[86:87] op_sel_hi:[1,0]
    v_pk_mul_f32 v[112:113], v[92:93], v[88:89] op_sel_hi:[1,0]
    v_pk_mul_f32 v[114:115], v[92:93], v[90:91] op_sel_hi:[1,0]
    v_pk_mul_f32 v[116:117], v[94:95], v[80:81] op_sel_hi:[1,0]
    v_pk_fma_f32 v[120:121], v[92:93], v[86:87], v[110:111] op_sel:[1,1,0] op_sel_hi:[0,1,1] neg_lo:[1,0,0]
    v_pk_fma_f32 v[122:123], v[92:93], v[88:89], v[112:113] op_sel:[1,1,0] op_sel_hi:[0,1,1] neg_lo:[1,0,0]
    v_pk_fma_f32 v[124:125], v[92:93], v[90:91], v[114:115] op_sel:[1,1,0] op_sel_hi:[0,1,1] neg_lo:[1,0,0]
    v_pk_fma_f32 v[126:127], v[94:95], v[80:81], v[116:117] op_sel:[1,1,0] op_sel_hi:[0,1,1] neg_lo:[1,0,0]
    v_cvt_pk_bf16_f32 v157, v120, v121
    ds_write2st64_b32 v26, v156, v157 offset0:12 offset1:13
    v_cvt_pk_bf16_f32 v158, v122, v123
    v_cvt_pk_bf16_f32 v159, v124, v125
    ds_write2st64_b32 v27, v158, v159 offset0:14 offset1:15
    v_cvt_pk_bf16_f32 v161, v126, v127
    v_pk_mul_f32 v[110:111], v[94:95], v[84:85] op_sel_hi:[1,0]
    v_pk_mul_f32 v[112:113], v[94:95], v[88:89] op_sel_hi:[1,0]
    v_pk_mul_f32 v[114:115], v[96:97], v[80:81] op_sel_hi:[1,0]
    v_pk_mul_f32 v[116:117], v[96:97], v[84:85] op_sel_hi:[1,0]
    v_pk_fma_f32 v[120:121], v[94:95], v[84:85], v[110:111] op_sel:[1,1,0] op_sel_hi:[0,1,1] neg_lo:[1,0,0]
    v_pk_fma_f32 v[122:123], v[94:95], v[88:89], v[112:113] op_sel:[1,1,0] op_sel_hi:[0,1,1] neg_lo:[1,0,0]
    v_pk_fma_f32 v[124:125], v[96:97], v[80:81], v[114:115] op_sel:[1,1,0] op_sel_hi:[0,1,1] neg_lo:[1,0,0]
    v_pk_fma_f32 v[126:127], v[96:97], v[84:85], v[116:117] op_sel:[1,1,0] op_sel_hi:[0,1,1] neg_lo:[1,0,0]
    ds_read_b128 v[208:211], v28
    ds_read_b128 v[212:215], v29
    ds_read_b128 v[216:219], v30
    ds_read_b128 v[220:223], v31
    ds_write2st64_b32 v20, v160, v161 offset0:0 offset1:1
    v_cvt_pk_bf16_f32 v162, v120, v121
    v_cvt_pk_bf16_f32 v163, v122, v123
    ds_write2st64_b32 v21, v162, v163 offset0:2 offset1:3
    v_cvt_pk_bf16_f32 v165, v124, v125
    ds_write2st64_b32 v22, v164, v165 offset0:4 offset1:5
    v_cvt_pk_bf16_f32 v166, v126, v127
    v_pk_mul_f32 v[110:111], v[96:97], v[88:89] op_sel_hi:[1,0]
    v_pk_mul_f32 v[112:113], v[98:99], v[84:85] op_sel_hi:[1,0]
    v_pk_mul_f32 v[114:115], v[100:101], v[84:85] op_sel_hi:[1,0]
    v_pk_mul_f32 v[116:117], v[102:103], v[84:85] op_sel_hi:[1,0]
    v_pk_fma_f32 v[120:121], v[96:97], v[88:89], v[110:111] op_sel:[1,1,0] op_sel_hi:[0,1,1] neg_lo:[1,0,0]
    v_pk_fma_f32 v[122:123], v[98:99], v[84:85], v[112:113] op_sel:[1,1,0] op_sel_hi:[0,1,1] neg_lo:[1,0,0]
    v_pk_fma_f32 v[124:125], v[100:101], v[84:85], v[114:115] op_sel:[1,1,0] op_sel_hi:[0,1,1] neg_lo:[1,0,0]
    v_pk_fma_f32 v[126:127], v[102:103], v[84:85], v[116:117] op_sel:[1,1,0] op_sel_hi:[0,1,1] neg_lo:[1,0,0]
    v_cvt_pk_bf16_f32 v167, v120, v121
    ds_write2st64_b32 v23, v166, v167 offset0:6 offset1:7
    v_cvt_pk_bf16_f32 v169, v122, v123
    ds_write2st64_b32 v24, v168, v169 offset0:8 offset1:9
    v_cvt_pk_bf16_f32 v171, v124, v125
    ds_write2st64_b32 v25, v170, v171 offset0:10 offset1:11
    v_cvt_pk_bf16_f32 v173, v126, v127
    v_pk_mul_f32 v[110:111], v[104:105], v[84:85] op_sel_hi:[1,0]
    v_pk_mul_f32 v[112:113], v[66:67], v[92:93] op_sel_hi:[1,0]
    v_pk_mul_f32 v[114:115], v[66:67], v[94:95] op_sel_hi:[1,0]
    v_pk_mul_f32 v[116:117], v[66:67], v[96:97] op_sel_hi:[1,0]
    v_pk_fma_f32 v[120:121], v[104:105], v[84:85], v[110:111] op_sel:[1,1,0] op_sel_hi:[0,1,1] neg_lo:[1,0,0]
    v_pk_fma_f32 v[122:123], v[66:67], v[92:93], v[112:113] op_sel:[1,1,0] op_sel_hi:[0,1,1] neg_lo:[1,0,0]
    v_pk_fma_f32 v[124:125], v[66:67], v[94:95], v[114:115] op_sel:[1,1,0] op_sel_hi:[0,1,1] neg_lo:[1,0,0]
    v_pk_fma_f32 v[126:127], v[66:67], v[96:97], v[116:117] op_sel:[1,1,0] op_sel_hi:[0,1,1] neg_lo:[1,0,0]
    ds_write2st64_b32 v26, v172, v173 offset0:12 offset1:13
    v_cvt_pk_bf16_f32 v175, v120, v121
    ds_write2st64_b32 v27, v174, v175 offset0:14 offset1:15
    v_cvt_pk_bf16_f32 v177, v122, v123
    ds_read_b128 v[224:227], v28
    ds_read_b128 v[228:231], v29
    ds_read_b128 v[232:235], v30
    ds_read_b128 v[236:239], v31
    ds_write2st64_b32 v20, v176, v177 offset0:0 offset1:1
    v_cvt_pk_bf16_f32 v178, v124, v125
    v_cvt_pk_bf16_f32 v179, v126, v127
    v_pk_mul_f32 v[110:111], v[66:67], v[98:99] op_sel_hi:[1,0]
    v_pk_mul_f32 v[112:113], v[66:67], v[100:101] op_sel_hi:[1,0]
    v_pk_mul_f32 v[114:115], v[66:67], v[102:103] op_sel_hi:[1,0]
    v_pk_mul_f32 v[116:117], v[66:67], v[104:105] op_sel_hi:[1,0]
    v_pk_fma_f32 v[120:121], v[66:67], v[98:99], v[110:111] op_sel:[1,1,0] op_sel_hi:[0,1,1] neg_lo:[1,0,0]
    v_pk_fma_f32 v[122:123], v[66:67], v[100:101], v[112:113] op_sel:[1,1,0] op_sel_hi:[0,1,1] neg_lo:[1,0,0]
    v_pk_fma_f32 v[124:125], v[66:67], v[102:103], v[114:115] op_sel:[1,1,0] op_sel_hi:[0,1,1] neg_lo:[1,0,0]
    v_pk_fma_f32 v[126:127], v[66:67], v[104:105], v[116:117] op_sel:[1,1,0] op_sel_hi:[0,1,1] neg_lo:[1,0,0]
    ds_write2st64_b32 v21, v178, v179 offset0:2 offset1:3
    v_cvt_pk_bf16_f32 v180, v120, v121
    v_cvt_pk_bf16_f32 v181, v122, v123
    ds_write2st64_b32 v22, v180, v181 offset0:4 offset1:5
    v_cvt_pk_bf16_f32 v182, v124, v125
    v_cvt_pk_bf16_f32 v183, v126, v127
    v_pk_mul_f32 v[110:111], v[66:67], v[66:67] op_sel_hi:[1,0]
    v_pk_fma_f32 v[120:121], v[66:67], v[66:67], v[110:111] op_sel:[1,1,0] op_sel_hi:[0,1,1] neg_lo:[1,0,0]
    ds_write2st64_b32 v23, v182, v183 offset0:6 offset1:7
    v_cvt_pk_bf16_f32 v184, v120, v121
    ds_write_b32 v24, v184 offset:2048
    ds_read_b128 v[240:243], v28
    ds_read_b128 v[244:247], v29
    ds_read_b128 v[248:251], v30
    ds_read_b128 v[252:255], v31
    s_waitcnt lgkmcnt(0)
    v_mfma_f32_16x16x32_bf16 v[128:131], v[208:211], v[192:195], 0
    v_mfma_f32_16x16x32_bf16 v[132:135], v[224:227], v[192:195], 0
    v_mfma_f32_16x16x32_bf16 v[136:139], v[240:243], v[192:195], 0
    v_mfma_f32_16x16x32_bf16 v[128:131], v[212:215], v[196:199], v[128:131]
    v_mfma_f32_16x16x32_bf16 v[132:135], v[228:231], v[196:199], v[132:135]
    v_mfma_f32_16x16x32_bf16 v[136:139], v[244:247], v[196:199], v[136:139]
    v_mfma_f32_16x16x32_bf16 v[128:131], v[216:219], v[200:203], v[128:131]
    v_mfma_f32_16x16x32_bf16 v[132:135], v[232:235], v[200:203], v[132:135]
    v_mfma_f32_16x16x32_bf16 v[136:139], v[248:251], v[200:203], v[136:139]
    v_mfma_f32_16x16x32_bf16 v[128:131], v[220:223], v[204:207], v[128:131]
    v_mfma_f32_16x16x32_bf16 v[132:135], v[236:239], v[204:207], v[132:135]
    v_mfma_f32_16x16x32_bf16 v[136:139], v[252:255], v[204:207], v[136:139]
    s_mul_i32 s40, s5, 3072
    s_add_u32 s40, s40, 155648
    v_lshl_add_u32 v2, v1, 4, s40
    s_lshl_b32 s41, s5, 2
    v_add_u32 v3, s41, v6
    s_bitcmp1_b32 s56, 0
    s_cbranch_scc0 F_kr_34
    s_nop 1
    ds_write_b128 v2, v[128:131] offset:0
    ds_write_b128 v2, v[132:135] offset:1024
    ds_write_b128 v2, v[136:139] offset:2048
    s_waitcnt lgkmcnt(0)
    s_barrier
    ds_write_b32 v3, v7 offset:16
    s_branch F_kd_35
F_kr_34:
    s_barrier
    ds_read_b128 v[140:143], v2 offset:0
    ds_read_b128 v[144:147], v2 offset:1024
    ds_read_b128 v[148:151], v2 offset:2048
    s_waitcnt lgkmcnt(0)
    v_add_f32 v128, v128, v140
    v_add_f32 v129, v129, v141
    v_add_f32 v130, v130, v142
    v_add_f32 v131, v131, v143
    v_add_f32 v132, v132, v144
    v_add_f32 v133, v133, v145
    v_add_f32 v134, v134, v146
    v_add_f32 v135, v135, v147
    v_add_f32 v136, v136, v148
    v_add_f32 v137, v137, v149
    v_add_f32 v138, v138, v150
    v_add_f32 v139, v139, v151
    v_cvt_pk_bf16_f32 v140, v128, v129
    v_cvt_pk_bf16_f32 v141, v130, v131
    v_cvt_pk_bf16_f32 v142, v132, v133
    v_cvt_pk_bf16_f32 v143, v134, v135
    v_cvt_pk_bf16_f32 v144, v136, v137
    v_cvt_pk_bf16_f32 v145, v138, v139
    ds_write_b64 v32, v[140:141]
    ds_write_b32 v33, v142 offset:512
    ds_write_b32 v34, v143 offset:512
    ds_write_b16 v35, v144 offset:1024
    ds_write_b16_d16_hi v35, v144 offset:1056
    ds_write_b16 v35, v145 offset:1088
    ds_write_b16_d16_hi v35, v145 offset:1120
F_kd_35:
    v_lshlrev_b32 v16, 4, v1
    v_mov_b32 v17, v44
    ds_read_b128 v[64:67], v12 offset:0
    ds_read_b128 v[68:71], v12 offset:2048
    ds_read_b128 v[72:75], v12 offset:4096
    ds_read_b128 v[76:79], v12 offset:6144
    ds_read_b64_tr_b16 v[32:33], v8 offset:0
    ds_read_b64_tr_b16 v[34:35], v8 offset:2048
    ds_read_b64_tr_b16 v[36:37], v8 offset:1024
    ds_read_b64_tr_b16 v[38:39], v8 offset:3072
    ds_read_b64_tr_b16 v[40:41], v9 offset:0
    ds_read_b64_tr_b16 v[42:43], v9 offset:2048
    ds_read_b64_tr_b16 v[44:45], v9 offset:1024
    ds_read_b64_tr_b16 v[46:47], v9 offset:3072
    ds_read_b64_tr_b16 v[48:49], v10 offset:0
    ds_read_b64_tr_b16 v[50:51], v10 offset:2048
    ds_read_b64_tr_b16 v[52:53], v10 offset:1024
    ds_read_b64_tr_b16 v[54:55], v10 offset:3072
    ds_read_b64_tr_b16 v[56:57], v11 offset:0
    ds_read_b64_tr_b16 v[58:59], v11 offset:2048
    ds_read_b64_tr_b16 v[60:61], v11 offset:1024
    ds_read_b64_tr_b16 v[62:63], v11 offset:3072
    s_add_u32 s44, s44, 1
    s_cmp_eq_u32 s44, 6
    s_cselect_b32 s46, 4294885376, s52
    s_cselect_b32 s44, 0, s44
    v_add_u32 v8, s46, v8
    v_add_u32 v9, s46, v9
    v_add_u32 v10, s46, v10
    v_add_u32 v11, s46, v11
    s_waitcnt lgkmcnt(0)
    s_barrier
    s_mov_b32 s48, 7
    v_mfma_f32_16x16x32_bf16 v[128:131], v[32:35], v[64:67], 0
    ds_read_b128 v[112:115], v13 offset:0
    v_mfma_f32_16x16x32_bf16 v[160:163], v[32:35], v[68:71], 0
    ds_read_b128 v[116:119], v13 offset:2048
    v_mfma_f32_16x16x32_bf16 v[192:195], v[32:35], v[72:75], 0
    ds_read_b128 v[120:123], v13 offset:4096
    v_mfma_f32_16x16x32_bf16 v[224:227], v[32:35], v[76:79], 0
    ds_read_b128 v[124:127], v13 offset:6144
    v_mfma_f32_16x16x32_bf16 v[132:135], v[36:39], v[64:67], 0
    ds_read_b64_tr_b16 v[80:81], v8 offset:0
    v_mfma_f32_16x16x32_bf16 v[164:167], v[36:39], v[68:71], 0
    ds_read_b64_tr_b16 v[82:83], v8 offset:2048
    v_mfma_f32_16x16x32_bf16 v[196:199], v[36:39], v[72:75], 0
    ds_read_b64_tr_b16 v[84:85], v8 offset:1024
    v_mfma_f32_16x16x32_bf16 v[228:231], v[36:39], v[76:79], 0
    ds_read_b64_tr_b16 v[86:87], v8 offset:3072
    v_mfma_f32_16x16x32_bf16 v[136:139], v[40:43], v[64:67], 0
    ds_read_b64_tr_b16 v[88:89], v9 offset:0
    v_mfma_f32_16x16x32_bf16 v[168:171], v[40:43], v[68:71], 0
    ds_read_b64_tr_b16 v[90:91], v9 offset:2048
    v_mfma_f32_16x16x32_bf16 v[200:203], v[40:43], v[72:75], 0
    ds_read_b64_tr_b16 v[92:93], v9 offset:1024
    v_mfma_f32_16x16x32_bf16 v[232:235], v[40:43], v[76:79], 0
    ds_read_b64_tr_b16 v[94:95], v9 offset:3072
    v_mfma_f32_16x16x32_bf16 v[140:143], v[44:47], v[64:67], 0
    ds_read_b64_tr_b16 v[96:97], v10 offset:0
    v_mfma_f32_16x16x32_bf16 v[172:175], v[44:47], v[68:71], 0
    ds_read_b64_tr_b16 v[98:99], v10 offset:2048
    v_mfma_f32_16x16x32_bf16 v[204:207], v[44:47], v[72:75], 0
    ds_read_b64_tr_b16 v[100:101], v10 offset:1024
    v_mfma_f32_16x16x32_bf16 v[236:239], v[44:47], v[76:79], 0
    ds_read_b64_tr_b16 v[102:103], v10 offset:3072
    v_mfma_f32_16x16x32_bf16 v[144:147], v[48:51], v[64:67], 0
    ds_read_b64_tr_b16 v[104:105], v11 offset:0
    v_mfma_f32_16x16x32_bf16 v[176:179], v[48:51], v[68:71], 0
    ds_read_b64_tr_b16 v[106:107], v11 offset:2048
    v_mfma_f32_16x16x32_bf16 v[208:211], v[48:51], v[72:75], 0
    ds_read_b64_tr_b16 v[108:109], v11 offset:1024
    v_mfma_f32_16x16x32_bf16 v[240:243], v[48:51], v[76:79], 0
    ds_read_b64_tr_b16 v[110:111], v11 offset:3072
    v_mfma_f32_16x16x32_bf16 v[148:151], v[52:55], v[64:67], 0
    s_add_u32 s44, s44, 1
    s_cmp_eq_u32 s44, 6
    s_cselect_b32 s46, 4294885376, s52
    v_mfma_f32_16x16x32_bf16 v[180:183], v[52:55], v[68:71], 0
    s_cselect_b32 s44, 0, s44
    v_add_u32 v8, s46, v8
    v_mfma_f32_16x16x32_bf16 v[212:215], v[52:55], v[72:75], 0
    v_add_u32 v9, s46, v9
    v_add_u32 v10, s46, v10
    v_mfma_f32_16x16x32_bf16 v[244:247], v[52:55], v[76:79], 0
    v_add_u32 v11, s46, v11
    s_add_u32 s45, s45, 2
    v_mfma_f32_16x16x32_bf16 v[152:155], v[56:59], v[64:67], 0
    s_cmp_ge_u32 s45, 7
    s_cselect_b32 s47, 4294926336, s52
    v_mfma_f32_16x16x32_bf16 v[184:187], v[56:59], v[68:71], 0
    s_cselect_b32 s49, 7, 0
    s_sub_u32 s45, s45, s49
    v_mfma_f32_16x16x32_bf16 v[216:219], v[56:59], v[72:75], 0
    v_add_u32 v12, s47, v12
    v_add_u32 v13, s47, v13
    v_mfma_f32_16x16x32_bf16 v[248:251], v[56:59], v[76:79], 0
    s_waitcnt lgkmcnt(0)
    s_barrier
    v_mfma_f32_16x16x32_bf16 v[156:159], v[60:63], v[64:67], 0
    v_mfma_f32_16x16x32_bf16 v[188:191], v[60:63], v[68:71], 0
    v_mfma_f32_16x16x32_bf16 v[220:223], v[60:63], v[72:75], 0
    v_mfma_f32_16x16x32_bf16 v[252:255], v[60:63], v[76:79], 0
    s_branch F_g1mid_37
F_g1loop_36:
    v_mfma_f32_16x16x32_bf16 v[128:131], v[32:35], v[64:67], v[128:131]
    ds_read_b128 v[112:115], v13 offset:0
    v_mfma_f32_16x16x32_bf16 v[160:163], v[32:35], v[68:71], v[160:163]
    ds_read_b128 v[116:119], v13 offset:2048
    v_mfma_f32_16x16x32_bf16 v[192:195], v[32:35], v[72:75], v[192:195]
    ds_read_b128 v[120:123], v13 offset:4096
    v_mfma_f32_16x16x32_bf16 v[224:227], v[32:35], v[76:79], v[224:227]
    ds_read_b128 v[124:127], v13 offset:6144
    v_mfma_f32_16x16x32_bf16 v[132:135], v[36:39], v[64:67], v[132:135]
    ds_read_b64_tr_b16 v[80:81], v8 offset:0
    v_mfma_f32_16x16x32_bf16 v[164:167], v[36:39], v[68:71], v[164:167]
    ds_read_b64_tr_b16 v[82:83], v8 offset:2048
    v_mfma_f32_16x16x32_bf16 v[196:199], v[36:39], v[72:75], v[196:199]
    ds_read_b64_tr_b16 v[84:85], v8 offset:1024
    v_mfma_f32_16x16x32_bf16 v[228:231], v[36:39], v[76:79], v[228:231]
    ds_read_b64_tr_b16 v[86:87], v8 offset:3072
    v_mfma_f32_16x16x32_bf16 v[136:139], v[40:43], v[64:67], v[136:139]
    ds_read_b64_tr_b16 v[88:89], v9 offset:0
    v_mfma_f32_16x16x32_bf16 v[168:171], v[40:43], v[68:71], v[168:171]
    ds_read_b64_tr_b16 v[90:91], v9 offset:2048
    v_mfma_f32_16x16x32_bf16 v[200:203], v[40:43], v[72:75], v[200:203]
    ds_read_b64_tr_b16 v[92:93], v9 offset:1024
    v_mfma_f32_16x16x32_bf16 v[232:235], v[40:43], v[76:79], v[232:235]
    ds_read_b64_tr_b16 v[94:95], v9 offset:3072
    v_mfma_f32_16x16x32_bf16 v[140:143], v[44:47], v[64:67], v[140:143]
    ds_read_b64_tr_b16 v[96:97], v10 offset:0
    v_mfma_f32_16x16x32_bf16 v[172:175], v[44:47], v[68:71], v[172:175]
    ds_read_b64_tr_b16 v[98:99], v10 offset:2048
    v_mfma_f32_16x16x32_bf16 v[204:207], v[44:47], v[72:75], v[204:207]
    ds_read_b64_tr_b16 v[100:101], v10 offset:1024
    v_mfma_f32_16x16x32_bf16 v[236:239], v[44:47], v[76:79], v[236:239]
    ds_read_b64_tr_b16 v[102:103], v10 offset:3072
    v_mfma_f32_16x16x32_bf16 v[144:147], v[48:51], v[64:67], v[144:147]
    ds_read_b64_tr_b16 v[104:105], v11 offset:0
    v_mfma_f32_16x16x32_bf16 v[176:179], v[48:51], v[68:71], v[176:179]
    ds_read_b64_tr_b16 v[106:107], v11 offset:2048
    v_mfma_f32_16x16x32_bf16 v[208:211], v[48:51], v[72:75], v[208:211]
    ds_read_b64_tr_b16 v[108:109], v11 offset:1024
    v_mfma_f32_16x16x32_bf16 v[240:243], v[48:51], v[76:79], v[240:243]
    ds_read_b64_tr_b16 v[110:111], v11 offset:3072
    v_mfma_f32_16x16x32_bf16 v[148:151], v[52:55], v[64:67], v[148:151]
    s_add_u32 s44, s44, 1
    s_cmp_eq_u32 s44, 6
    s_cselect_b32 s46, 4294885376, s52
    v_mfma_f32_16x16x32_bf16 v[180:183], v[52:55], v[68:71], v[180:183]
    s_cselect_b32 s44, 0, s44
    v_add_u32 v8, s46, v8
    v_mfma_f32_16x16x32_bf16 v[212:215], v[52:55], v[72:75], v[212:215]
    v_add_u32 v9, s46, v9
    v_add_u32 v10, s46, v10
    v_mfma_f32_16x16x32_bf16 v[244:247], v[52:55], v[76:79], v[244:247]
    v_add_u32 v11, s46, v11
    s_add_u32 s45, s45, 2
    v_mfma_f32_16x16x32_bf16 v[152:155], v[56:59], v[64:67], v[152:155]
    s_cmp_ge_u32 s45, 7
    s_cselect_b32 s47, 4294926336, s52
    v_mfma_f32_16x16x32_bf16 v[184:187], v[56:59], v[68:71], v[184:187]
    s_cselect_b32 s49, 7, 0
    s_sub_u32 s45, s45, s49
    v_mfma_f32_16x16x32_bf16 v[216:219], v[56:59], v[72:75], v[216:219]
    v_add_u32 v12, s47, v12
    v_add_u32 v13, s47, v13
    v_mfma_f32_16x16x32_bf16 v[248:251], v[56:59], v[76:79], v[248:251]
    s_waitcnt lgkmcnt(0)
    s_barrier
    v_mfma_f32_16x16x32_bf16 v[156:159], v[60:63], v[64:67], v[156:159]
    v_mfma_f32_16x16x32_bf16 v[188:191], v[60:63], v[68:71], v[188:191]
    v_mfma_f32_16x16x32_bf16 v[220:223], v[60:63], v[72:75], v[220:223]
    v_mfma_f32_16x16x32_bf16 v[252:255], v[60:63], v[76:79], v[252:255]
F_g1mid_37:
    v_mfma_f32_16x16x32_bf16 v[128:131], v[80:83], v[112:115], v[128:131]
    ds_read_b128 v[64:67], v12 offset:0
    v_mfma_f32_16x16x32_bf16 v[160:163], v[80:83], v[116:119], v[160:163]
    ds_read_b128 v[68:71], v12 offset:2048
    v_mfma_f32_16x16x32_bf16 v[192:195], v[80:83], v[120:123], v[192:195]
    ds_read_b128 v[72:75], v12 offset:4096
    v_mfma_f32_16x16x32_bf16 v[224:227], v[80:83], v[124:127], v[224:227]
    ds_read_b128 v[76:79], v12 offset:6144
    v_mfma_f32_16x16x32_bf16 v[132:135], v[84:87], v[112:115], v[132:135]
    ds_read_b64_tr_b16 v[32:33], v8 offset:0
    v_mfma_f32_16x16x32_bf16 v[164:167], v[84:87], v[116:119], v[164:167]
    ds_read_b64_tr_b16 v[34:35], v8 offset:2048
    v_mfma_f32_16x16x32_bf16 v[196:199], v[84:87], v[120:123], v[196:199]
    ds_read_b64_tr_b16 v[36:37], v8 offset:1024
    v_mfma_f32_16x16x32_bf16 v[228:231], v[84:87], v[124:127], v[228:231]
    ds_read_b64_tr_b16 v[38:39], v8 offset:3072
    v_mfma_f32_16x16x32_bf16 v[136:139], v[88:91], v[112:115], v[136:139]
    ds_read_b64_tr_b16 v[40:41], v9 offset:0
    v_mfma_f32_16x16x32_bf16 v[168:171], v[88:91], v[116:119], v[168:171]
    ds_read_b64_tr_b16 v[42:43], v9 offset:2048
    v_mfma_f32_16x16x32_bf16 v[200:203], v[88:91], v[120:123], v[200:203]
    ds_read_b64_tr_b16 v[44:45], v9 offset:1024
    v_mfma_f32_16x16x32_bf16 v[232:235], v[88:91], v[124:127], v[232:235]
    ds_read_b64_tr_b16 v[46:47], v9 offset:3072
    v_mfma_f32_16x16x32_bf16 v[140:143], v[92:95], v[112:115], v[140:143]
    ds_read_b64_tr_b16 v[48:49], v10 offset:0
    v_mfma_f32_16x16x32_bf16 v[172:175], v[92:95], v[116:119], v[172:175]
    ds_read_b64_tr_b16 v[50:51], v10 offset:2048
    v_mfma_f32_16x16x32_bf16 v[204:207], v[92:95], v[120:123], v[204:207]
    ds_read_b64_tr_b16 v[52:53], v10 offset:1024
    v_mfma_f32_16x16x32_bf16 v[236:239], v[92:95], v[124:127], v[236:239]
    ds_read_b64_tr_b16 v[54:55], v10 offset:3072
    v_mfma_f32_16x16x32_bf16 v[144:147], v[96:99], v[112:115], v[144:147]
    ds_read_b64_tr_b16 v[56:57], v11 offset:0
    v_mfma_f32_16x16x32_bf16 v[176:179], v[96:99], v[116:119], v[176:179]
    ds_read_b64_tr_b16 v[58:59], v11 offset:2048
    v_mfma_f32_16x16x32_bf16 v[208:211], v[96:99], v[120:123], v[208:211]
    ds_read_b64_tr_b16 v[60:61], v11 offset:1024
    v_mfma_f32_16x16x32_bf16 v[240:243], v[96:99], v[124:127], v[240:243]
    ds_read_b64_tr_b16 v[62:63], v11 offset:3072
    v_mfma_f32_16x16x32_bf16 v[148:151], v[100:103], v[112:115], v[148:151]
    s_add_u32 s44, s44, 1
    s_cmp_eq_u32 s44, 6
    v_mfma_f32_16x16x32_bf16 v[180:183], v[100:103], v[116:119], v[180:183]
    s_cselect_b32 s46, 4294885376, s52
    s_cselect_b32 s44, 0, s44
    v_mfma_f32_16x16x32_bf16 v[212:215], v[100:103], v[120:123], v[212:215]
    v_add_u32 v8, s46, v8
    v_add_u32 v9, s46, v9
    v_mfma_f32_16x16x32_bf16 v[244:247], v[100:103], v[124:127], v[244:247]
    v_add_u32 v10, s46, v10
    v_add_u32 v11, s46, v11
    v_mfma_f32_16x16x32_bf16 v[152:155], v[104:107], v[112:115], v[152:155]
    v_mfma_f32_16x16x32_bf16 v[184:187], v[104:107], v[116:119], v[184:187]
    v_mfma_f32_16x16x32_bf16 v[216:219], v[104:107], v[120:123], v[216:219]
    v_mfma_f32_16x16x32_bf16 v[248:251], v[104:107], v[124:127], v[248:251]
    s_waitcnt lgkmcnt(0)
    s_barrier
    v_mfma_f32_16x16x32_bf16 v[156:159], v[108:111], v[112:115], v[156:159]
    v_mfma_f32_16x16x32_bf16 v[188:191], v[108:111], v[116:119], v[188:191]
    v_mfma_f32_16x16x32_bf16 v[220:223], v[108:111], v[120:123], v[220:223]
    v_mfma_f32_16x16x32_bf16 v[252:255], v[108:111], v[124:127], v[252:255]
    s_sub_u32 s48, s48, 1
    s_cmp_lg_u32 s48, 0
    s_cbranch_scc1 F_g1loop_36
    v_mfma_f32_16x16x32_bf16 v[128:131], v[32:35], v[64:67], v[128:131]
    ds_read_b128 v[112:115], v13 offset:0
    v_mfma_f32_16x16x32_bf16 v[160:163], v[32:35], v[68:71], v[160:163]
    ds_read_b128 v[116:119], v13 offset:2048
    v_mfma_f32_16x16x32_bf16 v[192:195], v[32:35], v[72:75], v[192:195]
    ds_read_b128 v[120:123], v13 offset:4096
    v_mfma_f32_16x16x32_bf16 v[224:227], v[32:35], v[76:79], v[224:227]
    ds_read_b128 v[124:127], v13 offset:6144
    v_mfma_f32_16x16x32_bf16 v[132:135], v[36:39], v[64:67], v[132:135]
    ds_read_b64_tr_b16 v[80:81], v8 offset:0
    v_mfma_f32_16x16x32_bf16 v[164:167], v[36:39], v[68:71], v[164:167]
    ds_read_b64_tr_b16 v[82:83], v8 offset:2048
    v_mfma_f32_16x16x32_bf16 v[196:199], v[36:39], v[72:75], v[196:199]
    ds_read_b64_tr_b16 v[84:85], v8 offset:1024
    v_mfma_f32_16x16x32_bf16 v[228:231], v[36:39], v[76:79], v[228:231]
    ds_read_b64_tr_b16 v[86:87], v8 offset:3072
    v_mfma_f32_16x16x32_bf16 v[136:139], v[40:43], v[64:67], v[136:139]
    ds_read_b64_tr_b16 v[88:89], v9 offset:0
    v_mfma_f32_16x16x32_bf16 v[168:171], v[40:43], v[68:71], v[168:171]
    ds_read_b64_tr_b16 v[90:91], v9 offset:2048
    v_mfma_f32_16x16x32_bf16 v[200:203], v[40:43], v[72:75], v[200:203]
    ds_read_b64_tr_b16 v[92:93], v9 offset:1024
    v_mfma_f32_16x16x32_bf16 v[232:235], v[40:43], v[76:79], v[232:235]
    ds_read_b64_tr_b16 v[94:95], v9 offset:3072
    v_mfma_f32_16x16x32_bf16 v[140:143], v[44:47], v[64:67], v[140:143]
    ds_read_b64_tr_b16 v[96:97], v10 offset:0
    v_mfma_f32_16x16x32_bf16 v[172:175], v[44:47], v[68:71], v[172:175]
    ds_read_b64_tr_b16 v[98:99], v10 offset:2048
    v_mfma_f32_16x16x32_bf16 v[204:207], v[44:47], v[72:75], v[204:207]
    ds_read_b64_tr_b16 v[100:101], v10 offset:1024
    v_mfma_f32_16x16x32_bf16 v[236:239], v[44:47], v[76:79], v[236:239]
    ds_read_b64_tr_b16 v[102:103], v10 offset:3072
    v_mfma_f32_16x16x32_bf16 v[144:147], v[48:51], v[64:67], v[144:147]
    ds_read_b64_tr_b16 v[104:105], v11 offset:0
    v_mfma_f32_16x16x32_bf16 v[176:179], v[48:51], v[68:71], v[176:179]
    ds_read_b64_tr_b16 v[106:107], v11 offset:2048
    v_mfma_f32_16x16x32_bf16 v[208:211], v[48:51], v[72:75], v[208:211]
    ds_read_b64_tr_b16 v[108:109], v11 offset:1024
    v_mfma_f32_16x16x32_bf16 v[240:243], v[48:51], v[76:79], v[240:243]
    ds_read_b64_tr_b16 v[110:111], v11 offset:3072
    v_mfma_f32_16x16x32_bf16 v[148:151], v[52:55], v[64:67], v[148:151]
    v_mfma_f32_16x16x32_bf16 v[180:183], v[52:55], v[68:71], v[180:183]
    v_mfma_f32_16x16x32_bf16 v[212:215], v[52:55], v[72:75], v[212:215]
    v_mfma_f32_16x16x32_bf16 v[244:247], v[52:55], v[76:79], v[244:247]
    v_mfma_f32_16x16x32_bf16 v[152:155], v[56:59], v[64:67], v[152:155]
    v_mfma_f32_16x16x32_bf16 v[184:187], v[56:59], v[68:71], v[184:187]
    v_mfma_f32_16x16x32_bf16 v[216:219], v[56:59], v[72:75], v[216:219]
    v_mfma_f32_16x16x32_bf16 v[248:251], v[56:59], v[76:79], v[248:251]
    s_waitcnt lgkmcnt(0)
    s_barrier
    ds_read_b128 v[20:23], v17
    ds_read_b128 v[32:35], v14 offset:0
    v_mfma_f32_16x16x32_bf16 v[156:159], v[60:63], v[64:67], v[156:159]
    ds_read_b128 v[36:39], v14 offset:512
    ds_read_b128 v[40:43], v14 offset:64
    v_mfma_f32_16x16x32_bf16 v[188:191], v[60:63], v[68:71], v[188:191]
    ds_read_b128 v[44:47], v14 offset:576
    ds_read_b128 v[48:51], v14 offset:128
    v_mfma_f32_16x16x32_bf16 v[220:223], v[60:63], v[72:75], v[220:223]
    ds_read_b128 v[52:55], v14 offset:640
    v_mfma_f32_16x16x32_bf16 v[252:255], v[60:63], v[76:79], v[252:255]
    ds_read_b128 v[56:59], v14 offset:192
    ds_read_b128 v[60:63], v14 offset:704
    v_mfma_f32_16x16x32_bf16 v[128:131], v[80:83], v[112:115], v[128:131]
    v_mfma_f32_16x16x32_bf16 v[132:135], v[84:87], v[112:115], v[132:135]
    v_mfma_f32_16x16x32_bf16 v[136:139], v[88:91], v[112:115], v[136:139]
    v_mfma_f32_16x16x32_bf16 v[140:143], v[92:95], v[112:115], v[140:143]
    s_waitcnt lgkmcnt(0)
    v_mfma_f32_16x16x32_bf16 v[160:163], v[80:83], v[116:119], v[160:163]
    v_fmac_f32 v192, v32, v22
    v_fmac_f32 v193, v33, v22
    v_fmac_f32 v194, v34, v22
    v_fmac_f32 v195, v35, v22
    v_fmac_f32 v196, v36, v22
    v_fmac_f32 v197, v37, v22
    v_mfma_f32_16x16x32_bf16 v[164:167], v[84:87], v[116:119], v[164:167]
    v_fmac_f32 v198, v38, v22
    v_fmac_f32 v199, v39, v22
    v_fmac_f32 v200, v40, v22
    v_fmac_f32 v201, v41, v22
    v_fmac_f32 v202, v42, v22
    v_fmac_f32 v203, v43, v22
    v_mfma_f32_16x16x32_bf16 v[168:171], v[88:91], v[116:119], v[168:171]
    v_fmac_f32 v204, v44, v22
    v_fmac_f32 v205, v45, v22
    v_fmac_f32 v206, v46, v22
    v_fmac_f32 v207, v47, v22
    v_mfma_f32_16x16x32_bf16 v[172:175], v[92:95], v[116:119], v[172:175]
    v_mfma_f32_16x16x32_bf16 v[192:195], v[80:83], v[120:123], v[192:195]
    v_fmac_f32 v128, v32, v20
    v_fmac_f32 v129, v33, v20
    v_fmac_f32 v130, v34, v20
    v_fmac_f32 v131, v35, v20
    v_fmac_f32 v132, v36, v20
    v_fmac_f32 v133, v37, v20
    v_mfma_f32_16x16x32_bf16 v[196:199], v[84:87], v[120:123], v[196:199]
    v_fmac_f32 v134, v38, v20
    v_fmac_f32 v135, v39, v20
    v_fmac_f32 v136, v40, v20
    v_fmac_f32 v137, v41, v20
    v_fmac_f32 v138, v42, v20
    v_fmac_f32 v139, v43, v20
    v_mfma_f32_16x16x32_bf16 v[200:203], v[88:91], v[120:123], v[200:203]
    v_fmac_f32 v140, v44, v20
    v_fmac_f32 v141, v45, v20
    v_fmac_f32 v142, v46, v20
    v_fmac_f32 v143, v47, v20
    v_mul_f32 v128, v128, v132
    v_mul_f32 v129, v129, v133
    v_mfma_f32_16x16x32_bf16 v[204:207], v[92:95], v[120:123], v[204:207]
    v_mul_f32 v130, v130, v134
    v_mul_f32 v131, v131, v135
    v_mul_f32 v136, v136, v140
    v_mul_f32 v137, v137, v141
    v_mul_f32 v138, v138, v142
    v_mul_f32 v139, v139, v143
    v_mfma_f32_16x16x32_bf16 v[224:227], v[80:83], v[124:127], v[224:227]
    v_cvt_pk_bf16_f32 v132, v128, v129
    v_cvt_pk_bf16_f32 v133, v130, v131
    v_cvt_pk_bf16_f32 v134, v136, v137
    v_cvt_pk_bf16_f32 v135, v138, v139
    buffer_store_dwordx4 v[132:135], v16, s[8:11], s50 offen offset:0 sc1
    v_fmac_f32 v160, v32, v21
    v_mfma_f32_16x16x32_bf16 v[228:231], v[84:87], v[124:127], v[228:231]
    v_fmac_f32 v161, v33, v21
    v_fmac_f32 v162, v34, v21
    v_fmac_f32 v163, v35, v21
    v_fmac_f32 v164, v36, v21
    v_fmac_f32 v165, v37, v21
    v_fmac_f32 v166, v38, v21
    v_mfma_f32_16x16x32_bf16 v[232:235], v[88:91], v[124:127], v[232:235]
    v_fmac_f32 v167, v39, v21
    v_fmac_f32 v168, v40, v21
    v_fmac_f32 v169, v41, v21
    v_fmac_f32 v170, v42, v21
    v_fmac_f32 v171, v43, v21
    v_fmac_f32 v172, v44, v21
    v_mfma_f32_16x16x32_bf16 v[236:239], v[92:95], v[124:127], v[236:239]
    v_fmac_f32 v173, v45, v21
    v_fmac_f32 v174, v46, v21
    v_fmac_f32 v175, v47, v21
    v_mul_f32 v160, v160, v164
    v_mul_f32 v161, v161, v165
    v_mul_f32 v162, v162, v166
    v_mfma_f32_16x16x32_bf16 v[144:147], v[96:99], v[112:115], v[144:147]
    v_mul_f32 v163, v163, v167
    v_mul_f32 v168, v168, v172
    v_mul_f32 v169, v169, v173
    v_mul_f32 v170, v170, v174
    v_mul_f32 v171, v171, v175
    v_cvt_pk_bf16_f32 v164, v160, v161
    v_mfma_f32_16x16x32_bf16 v[148:151], v[100:103], v[112:115], v[148:151]
    v_cvt_pk_bf16_f32 v165, v162, v163
    v_cvt_pk_bf16_f32 v166, v168, v169
    v_cvt_pk_bf16_f32 v167, v170, v171
    buffer_store_dwordx4 v[164:167], v16, s[8:11], s50 offen offset:1024 sc1
    v_mul_f32 v192, v192, v196
    v_mul_f32 v193, v193, v197
    v_mfma_f32_16x16x32_bf16 v[152:155], v[104:107], v[112:115], v[152:155]
    v_mul_f32 v194, v194, v198
    v_mul_f32 v195, v195, v199
    v_mul_f32 v200, v200, v204
    v_mul_f32 v201, v201, v205
    v_mul_f32 v202, v202, v206
    v_mul_f32 v203, v203, v207
    v_mfma_f32_16x16x32_bf16 v[156:159], v[108:111], v[112:115], v[156:159]
    v_cvt_pk_bf16_f32 v196, v192, v193
    v_cvt_pk_bf16_f32 v197, v194, v195
    v_cvt_pk_bf16_f32 v198, v200, v201
    v_cvt_pk_bf16_f32 v199, v202, v203
    buffer_store_dwordx4 v[196:199], v16, s[8:11], s50 offen offset:2048 sc1
    v_mfma_f32_16x16x32_bf16 v[176:179], v[96:99], v[116:119], v[176:179]
    v_fmac_f32 v224, v32, v23
    v_fmac_f32 v225, v33, v23
    v_fmac_f32 v226, v34, v23
    v_fmac_f32 v227, v35, v23
    v_fmac_f32 v228, v36, v23
    v_fmac_f32 v229, v37, v23
    v_mfma_f32_16x16x32_bf16 v[180:183], v[100:103], v[116:119], v[180:183]
    v_fmac_f32 v230, v38, v23
    v_fmac_f32 v231, v39, v23
    v_fmac_f32 v232, v40, v23
    v_fmac_f32 v233, v41, v23
    v_fmac_f32 v234, v42, v23
    v_fmac_f32 v235, v43, v23
    v_mfma_f32_16x16x32_bf16 v[184:187], v[104:107], v[116:119], v[184:187]
    v_fmac_f32 v236, v44, v23
    v_fmac_f32 v237, v45, v23
    v_fmac_f32 v238, v46, v23
    v_fmac_f32 v239, v47, v23
    v_mul_f32 v224, v224, v228
    v_mul_f32 v225, v225, v229
    v_mfma_f32_16x16x32_bf16 v[188:191], v[108:111], v[116:119], v[188:191]
    v_mul_f32 v226, v226, v230
    v_mul_f32 v227, v227, v231
    v_mul_f32 v232, v232, v236
    v_mul_f32 v233, v233, v237
    v_mul_f32 v234, v234, v238
    v_mul_f32 v235, v235, v239
    v_mfma_f32_16x16x32_bf16 v[208:211], v[96:99], v[120:123], v[208:211]
    v_cvt_pk_bf16_f32 v228, v224, v225
    v_cvt_pk_bf16_f32 v229, v226, v227
    v_cvt_pk_bf16_f32 v230, v232, v233
    v_cvt_pk_bf16_f32 v231, v234, v235
    buffer_store_dwordx4 v[228:231], v16, s[8:11], s50 offen offset:3072 sc1
    v_fmac_f32 v144, v48, v20
    v_mfma_f32_16x16x32_bf16 v[212:215], v[100:103], v[120:123], v[212:215]
    v_fmac_f32 v145, v49, v20
    v_fmac_f32 v146, v50, v20
    v_fmac_f32 v147, v51, v20
    v_fmac_f32 v148, v52, v20
    v_fmac_f32 v149, v53, v20
    v_fmac_f32 v150, v54, v20
    v_mfma_f32_16x16x32_bf16 v[216:219], v[104:107], v[120:123], v[216:219]
    v_fmac_f32 v151, v55, v20
    v_fmac_f32 v152, v56, v20
    v_fmac_f32 v153, v57, v20
    v_fmac_f32 v154, v58, v20
    v_fmac_f32 v155, v59, v20
    v_fmac_f32 v156, v60, v20
    v_mfma_f32_16x16x32_bf16 v[220:223], v[108:111], v[120:123], v[220:223]
    v_fmac_f32 v157, v61, v20
    v_fmac_f32 v158, v62, v20
    v_fmac_f32 v159, v63, v20
    v_mul_f32 v144, v144, v148
    v_mul_f32 v145, v145, v149
    v_mul_f32 v146, v146, v150
    v_mfma_f32_16x16x32_bf16 v[240:243], v[96:99], v[124:127], v[240:243]
    v_mul_f32 v147, v147, v151
    v_mul_f32 v152, v152, v156
    v_mul_f32 v153, v153, v157
    v_mul_f32 v154, v154, v158
    v_mul_f32 v155, v155, v159
    v_cvt_pk_bf16_f32 v148, v144, v145
    v_mfma_f32_16x16x32_bf16 v[244:247], v[100:103], v[124:127], v[244:247]
    v_cvt_pk_bf16_f32 v149, v146, v147
    v_cvt_pk_bf16_f32 v150, v152, v153
    v_cvt_pk_bf16_f32 v151, v154, v155
    buffer_store_dwordx4 v[148:151], v16, s[8:11], s51 offen offset:0 sc1
    v_fmac_f32 v176, v48, v21
    v_fmac_f32 v177, v49, v21
    v_mfma_f32_16x16x32_bf16 v[248:251], v[104:107], v[124:127], v[248:251]
    v_fmac_f32 v178, v50, v21
    v_fmac_f32 v179, v51, v21
    v_fmac_f32 v180, v52, v21
    v_fmac_f32 v181, v53, v21
    v_fmac_f32 v182, v54, v21
    v_fmac_f32 v183, v55, v21
    v_mfma_f32_16x16x32_bf16 v[252:255], v[108:111], v[124:127], v[252:255]
    v_fmac_f32 v184, v56, v21
    v_fmac_f32 v185, v57, v21
    v_fmac_f32 v186, v58, v21
    v_fmac_f32 v187, v59, v21
    v_fmac_f32 v188, v60, v21
    v_fmac_f32 v189, v61, v21
    v_fmac_f32 v190, v62, v21
    v_fmac_f32 v191, v63, v21
    v_mul_f32 v176, v176, v180
    v_mul_f32 v177, v177, v181
    v_mul_f32 v178, v178, v182
    v_mul_f32 v179, v179, v183
    v_mul_f32 v184, v184, v188
    v_mul_f32 v185, v185, v189
    v_mul_f32 v186, v186, v190
    v_mul_f32 v187, v187, v191
    v_cvt_pk_bf16_f32 v180, v176, v177
    v_cvt_pk_bf16_f32 v181, v178, v179
    v_cvt_pk_bf16_f32 v182, v184, v185
    v_cvt_pk_bf16_f32 v183, v186, v187
    buffer_store_dwordx4 v[180:183], v16, s[8:11], s51 offen offset:1024 sc1
    v_fmac_f32 v208, v48, v22
    v_fmac_f32 v209, v49, v22
    v_fmac_f32 v210, v50, v22
    v_fmac_f32 v211, v51, v22
    v_fmac_f32 v212, v52, v22
    v_fmac_f32 v213, v53, v22
    v_fmac_f32 v214, v54, v22
    v_fmac_f32 v215, v55, v22
    v_fmac_f32 v216, v56, v22
    v_fmac_f32 v217, v57, v22
    v_fmac_f32 v218, v58, v22
    v_fmac_f32 v219, v59, v22
    v_fmac_f32 v220, v60, v22
    v_fmac_f32 v221, v61, v22
    v_fmac_f32 v222, v62, v22
    v_fmac_f32 v223, v63, v22
    v_mul_f32 v208, v208, v212
    v_mul_f32 v209, v209, v213
    v_mul_f32 v210, v210, v214
    v_mul_f32 v211, v211, v215
    v_mul_f32 v216, v216, v220
    v_mul_f32 v217, v217, v221
    v_mul_f32 v218, v218, v222
    v_mul_f32 v219, v219, v223
    v_cvt_pk_bf16_f32 v212, v208, v209
    v_cvt_pk_bf16_f32 v213, v210, v211
    v_cvt_pk_bf16_f32 v214, v216, v217
    v_cvt_pk_bf16_f32 v215, v218, v219
    buffer_store_dwordx4 v[212:215], v16, s[8:11], s51 offen offset:2048 sc1
    v_fmac_f32 v240, v48, v23
    v_fmac_f32 v241, v49, v23
    v_fmac_f32 v242, v50, v23
    v_fmac_f32 v243, v51, v23
    v_fmac_f32 v244, v52, v23
    v_fmac_f32 v245, v53, v23
    v_fmac_f32 v246, v54, v23
    v_fmac_f32 v247, v55, v23
    v_fmac_f32 v248, v56, v23
    v_fmac_f32 v249, v57, v23
    v_fmac_f32 v250, v58, v23
    v_fmac_f32 v251, v59, v23
    v_fmac_f32 v252, v60, v23
    v_fmac_f32 v253, v61, v23
    v_fmac_f32 v254, v62, v23
    v_fmac_f32 v255, v63, v23
    v_mul_f32 v240, v240, v244
    v_mul_f32 v241, v241, v245
    v_mul_f32 v242, v242, v246
    v_mul_f32 v243, v243, v247
    v_mul_f32 v248, v248, v252
    v_mul_f32 v249, v249, v253
    v_mul_f32 v250, v250, v254
    v_mul_f32 v251, v251, v255
    v_cvt_pk_bf16_f32 v244, v240, v241
    v_cvt_pk_bf16_f32 v245, v242, v243
    v_cvt_pk_bf16_f32 v246, v248, v249
    v_cvt_pk_bf16_f32 v247, v250, v251
    buffer_store_dwordx4 v[244:247], v16, s[8:11], s51 offen offset:3072 sc1
F_g2:
    s_setprio 3
    v_mov_b32 v6, 163328
    v_lshrrev_b32 v4, 4, v1
    v_bfe_u32 v2, v1, 3, 1
    v_and_b32 v3, 1, v4
    v_lshl_or_b32 v3, v3, 1, v2
    v_lshlrev_b32 v3, 5, v3
    v_and_b32 v4, 3, v1
    v_lshl_add_u32 v3, v4, 3, v3
    v_lshrrev_b32 v4, 2, v1
    v_lshl_add_u32 v3, v4, 7, v3
    s_lshl_b32 s52, s4, 12
    v_add_u32 v16, s52, v3
    v_xor_b32 v17, 32, v16
    v_xor_b32 v18, 64, v16
    v_xor_b32 v19, 96, v16
    v_add_u32 v20, 0x18000, v16
    v_add_u32 v28, 0x8000, v16
    v_add_u32 v21, 0x18000, v17
    v_add_u32 v29, 0x8000, v17
    v_add_u32 v22, 0x18000, v18
    v_add_u32 v30, 0x8000, v18
    v_add_u32 v23, 0x18000, v19
    v_add_u32 v31, 0x8000, v19
    v_lshrrev_b32 v2, 4, v1
    v_bfe_u32 v3, v1, 1, 2
    v_xor_b32 v3, v3, v2
    v_and_b32 v4, 1, v1
    v_lshl_or_b32 v3, v3, 1, v4
    v_lshrrev_b32 v4, 3, v1
    v_lshlrev_b32 v4, 10, v4
    v_lshl_add_u32 v11, v3, 4, v4
    s_lshl_b32 s41, s4, 2
    v_add_u32 v7, s41, v6
    s_mul_i32 s86, s4, 458752
    s_lshl_b32 s41, s54, 7
    s_add_u32 s86, s86, s41
    s_add_u32 s87, s86, 458752
    s_mul_i32 s44, s54, 7
    s_lshr_b32 s44, s44, 2
    s_add_u32 s51, s44, 3
    s_cmp_ge_u32 s51, 14
    s_cselect_b32 s41, 14, 0
    s_sub_u32 s51, s51, s41
    s_lshl_b32 s51, s51, 15
    s_add_u32 s51, s51, s86
    v_add_u32 v12, 7168, v11
    v_lshlrev_b32 v8, 4, v1
    v_lshlrev_b32 v13, 2, v1
    s_lshl_b32 s47, s53, 2
    s_add_u32 s47, s47, s4
    s_mul_i32 s47, s47, 3328
    s_add_u32 s47, s47, 10027008
    s_mul_i32 s45, s53, 56
    s_mul_i32 s48, s4, 14
    s_add_u32 s45, s45, s48
    s_lshl_b32 s88, s45, 12
    s_add_u32 s89, s88, 57344
    s_lshl_b32 s45, s44, 12
    s_add_u32 s45, s45, s88
    s_mov_b32 s58, 2097152
F_lw_39:
    ds_read_b32 v2, v7 offset:32
    s_waitcnt lgkmcnt(0)
    v_readfirstlane_b32 s40, v2
    s_cmp_ge_u32 s40, 1
    s_cbranch_scc1 F_lwd_40
    s_sleep 1
    s_sub_u32 s58, s58, 1
    s_cmp_lg_u32 s58, 0
    s_cbranch_scc1 F_lw_39
F_lwd_40:
    ds_read_b32 v5, v6 offset:8
    ds_read_b64_tr_b16 v[32:33], v28 offset:32768
    ds_read_b64_tr_b16 v[34:35], v28 offset:34816
    ds_read_b64_tr_b16 v[36:37], v29 offset:32768
    ds_read_b64_tr_b16 v[38:39], v29 offset:34816
    ds_read_b64_tr_b16 v[40:41], v30 offset:32768
    ds_read_b64_tr_b16 v[42:43], v30 offset:34816
    ds_read_b64_tr_b16 v[44:45], v31 offset:32768
    ds_read_b64_tr_b16 v[46:47], v31 offset:34816
    ds_read_b64_tr_b16 v[48:49], v28 offset:49152
    ds_read_b64_tr_b16 v[50:51], v28 offset:51200
    ds_read_b64_tr_b16 v[52:53], v29 offset:49152
    ds_read_b64_tr_b16 v[54:55], v29 offset:51200
    ds_read_b64_tr_b16 v[56:57], v30 offset:49152
    ds_read_b64_tr_b16 v[58:59], v30 offset:51200
    ds_read_b64_tr_b16 v[60:61], v31 offset:49152
    ds_read_b64_tr_b16 v[62:63], v31 offset:51200
    ds_read_b64_tr_b16 v[64:65], v16 offset:0
    ds_read_b64_tr_b16 v[66:67], v16 offset:2048
    ds_read_b64_tr_b16 v[68:69], v17 offset:0
    ds_read_b64_tr_b16 v[70:71], v17 offset:2048
    ds_read_b64_tr_b16 v[72:73], v18 offset:0
    ds_read_b64_tr_b16 v[74:75], v18 offset:2048
    ds_read_b64_tr_b16 v[76:77], v19 offset:0
    ds_read_b64_tr_b16 v[78:79], v19 offset:2048
    ds_read_b64_tr_b16 v[80:81], v16 offset:16384
    ds_read_b64_tr_b16 v[82:83], v16 offset:18432
    ds_read_b64_tr_b16 v[84:85], v17 offset:16384
    ds_read_b64_tr_b16 v[86:87], v17 offset:18432
    ds_read_b64_tr_b16 v[88:89], v18 offset:16384
    ds_read_b64_tr_b16 v[90:91], v18 offset:18432
    ds_read_b64_tr_b16 v[92:93], v19 offset:16384
    ds_read_b64_tr_b16 v[94:95], v19 offset:18432
    s_waitcnt lgkmcnt(0)
    v_readfirstlane_b32 s62, v5
    s_cmp_eq_u64 s[76:77], 0
    s_cbranch_scc1 F_nofl2_41
    s_waitcnt vmcnt(0)
    s_mov_b64 exec, 1
    buffer_store_dword v5, v15, s[8:11], s57 offen sc1
    s_mov_b64 exec, -1
F_nofl2_41:
    s_add_u32 s51, s51, 0x8000
    s_cmp_eq_u32 s51, s87
    s_cselect_b32 s51, s86, s51
    s_add_u32 m0, s52, 32768
    s_add_u32 s49, s51, 0
    buffer_load_dwordx4 v11, s[24:27], s49 offen lds
    buffer_load_dwordx4 v12, s[24:27], s49 offen offset:1024 lds
    s_add_u32 m0, s52, 34816
    s_add_u32 s49, s51, 16384
    buffer_load_dwordx4 v11, s[24:27], s49 offen lds
    buffer_load_dwordx4 v12, s[24:27], s49 offen offset:1024 lds
    s_add_u32 s51, s51, 0x8000
    s_cmp_eq_u32 s51, s87
    s_cselect_b32 s51, s86, s51
    s_add_u32 m0, s52, 49152
    s_add_u32 s49, s51, 0
    buffer_load_dwordx4 v11, s[24:27], s49 offen lds
    buffer_load_dwordx4 v12, s[24:27], s49 offen offset:1024 lds
    s_add_u32 m0, s52, 51200
    s_add_u32 s49, s51, 16384
    buffer_load_dwordx4 v11, s[24:27], s49 offen lds
    buffer_load_dwordx4 v12, s[24:27], s49 offen offset:1024 lds
    s_add_u32 s51, s51, 0x8000
    s_cmp_eq_u32 s51, s87
    s_cselect_b32 s51, s86, s51
    s_add_u32 m0, s52, 98304
    s_add_u32 s49, s51, 0
    buffer_load_dwordx4 v11, s[24:27], s49 offen lds
    buffer_load_dwordx4 v12, s[24:27], s49 offen offset:1024 lds
    s_add_u32 m0, s52, 100352
    s_add_u32 s49, s51, 16384
    buffer_load_dwordx4 v11, s[24:27], s49 offen lds
    buffer_load_dwordx4 v12, s[24:27], s49 offen offset:1024 lds
    s_add_u32 s51, s51, 0x8000
    s_cmp_eq_u32 s51, s87
    s_cselect_b32 s51, s86, s51
    s_add_u32 m0, s52, 65536
    s_add_u32 s49, s51, 0
    buffer_load_dwordx4 v11, s[24:27], s49 offen lds
    buffer_load_dwordx4 v12, s[24:27], s49 offen offset:1024 lds
    s_add_u32 m0, s52, 67584
    s_add_u32 s49, s51, 16384
    buffer_load_dwordx4 v11, s[24:27], s49 offen lds
    buffer_load_dwordx4 v12, s[24:27], s49 offen offset:1024 lds
    s_mov_b64 exec, 0x7f
    buffer_load_dword v2, v13, s[8:11], s47 offen sc1
    s_mov_b64 exec, -1
    s_add_u32 s51, s51, 0x8000
    s_cmp_eq_u32 s51, s87
    s_cselect_b32 s51, s86, s51
    s_add_u32 m0, s52, 81920
    s_add_u32 s49, s51, 0
    buffer_load_dwordx4 v11, s[24:27], s49 offen lds
    buffer_load_dwordx4 v12, s[24:27], s49 offen offset:1024 lds
    s_add_u32 m0, s52, 83968
    s_add_u32 s49, s51, 16384
    buffer_load_dwordx4 v11, s[24:27], s49 offen lds
    buffer_load_dwordx4 v12, s[24:27], s49 offen offset:1024 lds
    s_add_u32 s51, s51, 0x8000
    s_cmp_eq_u32 s51, s87
    s_cselect_b32 s51, s86, s51
    s_add_u32 m0, s52, 0
    s_add_u32 s49, s51, 0
    buffer_load_dwordx4 v11, s[24:27], s49 offen lds
    buffer_load_dwordx4 v12, s[24:27], s49 offen offset:1024 lds
    s_add_u32 m0, s52, 2048
    s_add_u32 s49, s51, 16384
    buffer_load_dwordx4 v11, s[24:27], s49 offen lds
    buffer_load_dwordx4 v12, s[24:27], s49 offen offset:1024 lds
    s_add_u32 s51, s51, 0x8000
    s_cmp_eq_u32 s51, s87
    s_cselect_b32 s51, s86, s51
    s_add_u32 m0, s52, 16384
    s_add_u32 s49, s51, 0
    buffer_load_dwordx4 v11, s[24:27], s49 offen lds
    buffer_load_dwordx4 v12, s[24:27], s49 offen offset:1024 lds
    s_add_u32 m0, s52, 18432
    s_add_u32 s49, s51, 16384
    buffer_load_dwordx4 v11, s[24:27], s49 offen lds
    buffer_load_dwordx4 v12, s[24:27], s49 offen offset:1024 lds
    s_waitcnt vmcnt(12)
    s_mov_b64 exec, 0x7f
    v_cmp_ne_u32 vcc, s62, v2
    s_mov_b64 exec, -1
    s_cbranch_vccz F_hok_42
    s_mov_b64 exec, 127
    s_mov_b32 s58, 2097152
F_poll_43:
    buffer_load_dword v2, v13, s[8:11], s47 offen sc1
    s_waitcnt vmcnt(0)
    v_cmp_ne_u32 vcc, s62, v2
    s_cbranch_vccz F_polld_44
    s_sleep 3
    s_sub_u32 s58, s58, 1
    s_cmp_lg_u32 s58, 0
    s_cbranch_scc1 F_poll_43
F_polld_44:
    s_mov_b64 exec, -1
F_hok_42:
    buffer_load_dwordx4 v[96:99], v8, s[8:11], s45 offen offset:0 sc1
    buffer_load_dwordx4 v[100:103], v8, s[8:11], s45 offen offset:1024 sc1
    buffer_load_dwordx4 v[104:107], v8, s[8:11], s45 offen offset:2048 sc1
    buffer_load_dwordx4 v[108:111], v8, s[8:11], s45 offen offset:3072 sc1
    s_add_u32 s45, s45, 4096
    s_cmp_eq_u32 s45, s89
    s_cselect_b32 s45, s88, s45
    buffer_load_dwordx4 v[112:115], v8, s[8:11], s45 offen offset:0 sc1
    buffer_load_dwordx4 v[116:119], v8, s[8:11], s45 offen offset:1024 sc1
    buffer_load_dwordx4 v[120:123], v8, s[8:11], s45 offen offset:2048 sc1
    buffer_load_dwordx4 v[124:127], v8, s[8:11], s45 offen offset:3072 sc1
    s_add_u32 s45, s45, 4096
    s_cmp_eq_u32 s45, s89
    s_cselect_b32 s45, s88, s45
    buffer_load_dwordx4 v[128:131], v8, s[8:11], s45 offen offset:0 sc1
    buffer_load_dwordx4 v[132:135], v8, s[8:11], s45 offen offset:1024 sc1
    buffer_load_dwordx4 v[136:139], v8, s[8:11], s45 offen offset:2048 sc1
    buffer_load_dwordx4 v[140:143], v8, s[8:11], s45 offen offset:3072 sc1
    s_add_u32 s45, s45, 4096
    s_cmp_eq_u32 s45, s89
    s_cselect_b32 s45, s88, s45
    buffer_load_dwordx4 v[208:211], v8, s[8:11], s45 offen offset:0 sc1
    buffer_load_dwordx4 v[212:215], v8, s[8:11], s45 offen offset:1024 sc1
    buffer_load_dwordx4 v[216:219], v8, s[8:11], s45 offen offset:2048 sc1
    buffer_load_dwordx4 v[220:223], v8, s[8:11], s45 offen offset:3072 sc1
    s_add_u32 s45, s45, 4096
    s_cmp_eq_u32 s45, s89
    s_cselect_b32 s45, s88, s45
    buffer_load_dwordx4 v[224:227], v8, s[8:11], s45 offen offset:0 sc1
    buffer_load_dwordx4 v[228:231], v8, s[8:11], s45 offen offset:1024 sc1
    buffer_load_dwordx4 v[232:235], v8, s[8:11], s45 offen offset:2048 sc1
    buffer_load_dwordx4 v[236:239], v8, s[8:11], s45 offen offset:3072 sc1
    s_add_u32 s45, s45, 4096
    s_cmp_eq_u32 s45, s89
    s_cselect_b32 s45, s88, s45
    buffer_load_dwordx4 v[240:243], v8, s[8:11], s45 offen offset:0 sc1
    buffer_load_dwordx4 v[244:247], v8, s[8:11], s45 offen offset:1024 sc1
    buffer_load_dwordx4 v[248:251], v8, s[8:11], s45 offen offset:2048 sc1
    buffer_load_dwordx4 v[252:255], v8, s[8:11], s45 offen offset:3072 sc1
    s_setprio 0
    s_waitcnt vmcnt(20)
    v_mfma_f32_16x16x32_bf16 v[144:147], v[32:35], v[96:99], 0
    v_mfma_f32_16x16x32_bf16 v[148:151], v[32:35], v[100:103], 0
    v_mfma_f32_16x16x32_bf16 v[152:155], v[32:35], v[104:107], 0
    v_mfma_f32_16x16x32_bf16 v[156:159], v[32:35], v[108:111], 0
    v_mfma_f32_16x16x32_bf16 v[160:163], v[36:39], v[96:99], 0
    v_mfma_f32_16x16x32_bf16 v[164:167], v[36:39], v[100:103], 0
    v_mfma_f32_16x16x32_bf16 v[168:171], v[36:39], v[104:107], 0
    v_mfma_f32_16x16x32_bf16 v[172:175], v[36:39], v[108:111], 0
    v_mfma_f32_16x16x32_bf16 v[176:179], v[40:43], v[96:99], 0
    v_mfma_f32_16x16x32_bf16 v[180:183], v[40:43], v[100:103], 0
    v_mfma_f32_16x16x32_bf16 v[184:187], v[40:43], v[104:107], 0
    v_mfma_f32_16x16x32_bf16 v[188:191], v[40:43], v[108:111], 0
    v_mfma_f32_16x16x32_bf16 v[192:195], v[44:47], v[96:99], 0
    v_mfma_f32_16x16x32_bf16 v[196:199], v[44:47], v[100:103], 0
    v_mfma_f32_16x16x32_bf16 v[200:203], v[44:47], v[104:107], 0
    v_mfma_f32_16x16x32_bf16 v[204:207], v[44:47], v[108:111], 0
    s_waitcnt vmcnt(16)
    v_mfma_f32_16x16x32_bf16 v[144:147], v[48:51], v[112:115], v[144:147]
    s_add_u32 s45, s45, 4096
    s_cmp_eq_u32 s45, s89
    s_cselect_b32 s45, s88, s45
    buffer_load_dwordx4 v[32:35], v8, s[8:11], s45 offen offset:0 sc1
    v_mfma_f32_16x16x32_bf16 v[148:151], v[48:51], v[116:119], v[148:151]
    v_mfma_f32_16x16x32_bf16 v[152:155], v[48:51], v[120:123], v[152:155]
    v_mfma_f32_16x16x32_bf16 v[156:159], v[48:51], v[124:127], v[156:159]
    buffer_load_dwordx4 v[36:39], v8, s[8:11], s45 offen offset:1024 sc1
    v_mfma_f32_16x16x32_bf16 v[160:163], v[52:55], v[112:115], v[160:163]
    v_mfma_f32_16x16x32_bf16 v[164:167], v[52:55], v[116:119], v[164:167]
    v_mfma_f32_16x16x32_bf16 v[168:171], v[52:55], v[120:123], v[168:171]
    buffer_load_dwordx4 v[40:43], v8, s[8:11], s45 offen offset:2048 sc1
    v_mfma_f32_16x16x32_bf16 v[172:175], v[52:55], v[124:127], v[172:175]
    v_mfma_f32_16x16x32_bf16 v[176:179], v[56:59], v[112:115], v[176:179]
    v_mfma_f32_16x16x32_bf16 v[180:183], v[56:59], v[116:119], v[180:183]
    buffer_load_dwordx4 v[44:47], v8, s[8:11], s45 offen offset:3072 sc1
    v_mfma_f32_16x16x32_bf16 v[184:187], v[56:59], v[120:123], v[184:187]
    v_mfma_f32_16x16x32_bf16 v[188:191], v[56:59], v[124:127], v[188:191]
    v_mfma_f32_16x16x32_bf16 v[192:195], v[60:63], v[112:115], v[192:195]
    s_add_u32 s45, s45, 4096
    s_cmp_eq_u32 s45, s89
    s_cselect_b32 s45, s88, s45
    buffer_load_dwordx4 v[96:99], v8, s[8:11], s45 offen offset:0 sc1
    v_mfma_f32_16x16x32_bf16 v[196:199], v[60:63], v[116:119], v[196:199]
    v_mfma_f32_16x16x32_bf16 v[200:203], v[60:63], v[120:123], v[200:203]
    v_mfma_f32_16x16x32_bf16 v[204:207], v[60:63], v[124:127], v[204:207]
    buffer_load_dwordx4 v[100:103], v8, s[8:11], s45 offen offset:1024 sc1
    s_waitcnt vmcnt(18)
    v_mfma_f32_16x16x32_bf16 v[144:147], v[64:67], v[128:131], v[144:147]
    buffer_load_dwordx4 v[104:107], v8, s[8:11], s45 offen offset:2048 sc1
    v_mfma_f32_16x16x32_bf16 v[148:151], v[64:67], v[132:135], v[148:151]
    v_mfma_f32_16x16x32_bf16 v[152:155], v[64:67], v[136:139], v[152:155]
    v_mfma_f32_16x16x32_bf16 v[156:159], v[64:67], v[140:143], v[156:159]
    buffer_load_dwordx4 v[108:111], v8, s[8:11], s45 offen offset:3072 sc1
    v_mfma_f32_16x16x32_bf16 v[160:163], v[68:71], v[128:131], v[160:163]
    v_mfma_f32_16x16x32_bf16 v[164:167], v[68:71], v[132:135], v[164:167]
    v_mfma_f32_16x16x32_bf16 v[168:171], v[68:71], v[136:139], v[168:171]
    s_add_u32 s45, s45, 4096
    s_cmp_eq_u32 s45, s89
    s_cselect_b32 s45, s88, s45
    buffer_load_dwordx4 v[48:51], v8, s[8:11], s45 offen offset:0 sc1
    v_mfma_f32_16x16x32_bf16 v[172:175], v[68:71], v[140:143], v[172:175]
    v_mfma_f32_16x16x32_bf16 v[176:179], v[72:75], v[128:131], v[176:179]
    v_mfma_f32_16x16x32_bf16 v[180:183], v[72:75], v[132:135], v[180:183]
    buffer_load_dwordx4 v[52:55], v8, s[8:11], s45 offen offset:1024 sc1
    v_mfma_f32_16x16x32_bf16 v[184:187], v[72:75], v[136:139], v[184:187]
    v_mfma_f32_16x16x32_bf16 v[188:191], v[72:75], v[140:143], v[188:191]
    v_mfma_f32_16x16x32_bf16 v[192:195], v[76:79], v[128:131], v[192:195]
    buffer_load_dwordx4 v[56:59], v8, s[8:11], s45 offen offset:2048 sc1
    v_mfma_f32_16x16x32_bf16 v[196:199], v[76:79], v[132:135], v[196:199]
    v_mfma_f32_16x16x32_bf16 v[200:203], v[76:79], v[136:139], v[200:203]
    v_mfma_f32_16x16x32_bf16 v[204:207], v[76:79], v[140:143], v[204:207]
    buffer_load_dwordx4 v[60:63], v8, s[8:11], s45 offen offset:3072 sc1
    s_waitcnt vmcnt(61)
    s_waitcnt vmcnt(20)
    v_mfma_f32_16x16x32_bf16 v[144:147], v[80:83], v[208:211], v[144:147]
    ds_read_b64_tr_b16 v[128:129], v16 offset:32768
    s_add_u32 s45, s45, 4096
    s_cmp_eq_u32 s45, s89
    s_cselect_b32 s45, s88, s45
    buffer_load_dwordx4 v[112:115], v8, s[8:11], s45 offen offset:0 sc1
    v_mfma_f32_16x16x32_bf16 v[148:151], v[80:83], v[212:215], v[148:151]
    ds_read_b64_tr_b16 v[130:131], v16 offset:34816
    v_mfma_f32_16x16x32_bf16 v[152:155], v[80:83], v[216:219], v[152:155]
    ds_read_b64_tr_b16 v[132:133], v17 offset:32768
    v_mfma_f32_16x16x32_bf16 v[156:159], v[80:83], v[220:223], v[156:159]
    ds_read_b64_tr_b16 v[134:135], v17 offset:34816
    buffer_load_dwordx4 v[116:119], v8, s[8:11], s45 offen offset:1024 sc1
    v_mfma_f32_16x16x32_bf16 v[160:163], v[84:87], v[208:211], v[160:163]
    ds_read_b64_tr_b16 v[136:137], v18 offset:32768
    v_mfma_f32_16x16x32_bf16 v[164:167], v[84:87], v[212:215], v[164:167]
    ds_read_b64_tr_b16 v[138:139], v18 offset:34816
    v_mfma_f32_16x16x32_bf16 v[168:171], v[84:87], v[216:219], v[168:171]
    ds_read_b64_tr_b16 v[140:141], v19 offset:32768
    buffer_load_dwordx4 v[120:123], v8, s[8:11], s45 offen offset:2048 sc1
    v_mfma_f32_16x16x32_bf16 v[172:175], v[84:87], v[220:223], v[172:175]
    ds_read_b64_tr_b16 v[142:143], v19 offset:34816
    v_mfma_f32_16x16x32_bf16 v[176:179], v[88:91], v[208:211], v[176:179]
    v_mfma_f32_16x16x32_bf16 v[180:183], v[88:91], v[212:215], v[180:183]
    buffer_load_dwordx4 v[124:127], v8, s[8:11], s45 offen offset:3072 sc1
    v_mfma_f32_16x16x32_bf16 v[184:187], v[88:91], v[216:219], v[184:187]
    v_mfma_f32_16x16x32_bf16 v[188:191], v[88:91], v[220:223], v[188:191]
    v_mfma_f32_16x16x32_bf16 v[192:195], v[92:95], v[208:211], v[192:195]
    s_add_u32 s45, s45, 4096
    s_cmp_eq_u32 s45, s89
    s_cselect_b32 s45, s88, s45
    buffer_load_dwordx4 v[64:67], v8, s[8:11], s45 offen offset:0 sc1
    v_mfma_f32_16x16x32_bf16 v[196:199], v[92:95], v[212:215], v[196:199]
    v_mfma_f32_16x16x32_bf16 v[200:203], v[92:95], v[216:219], v[200:203]
    v_mfma_f32_16x16x32_bf16 v[204:207], v[92:95], v[220:223], v[204:207]
    buffer_load_dwordx4 v[68:71], v8, s[8:11], s45 offen offset:1024 sc1
    s_waitcnt vmcnt(63)
    s_waitcnt vmcnt(22) lgkmcnt(0)
    v_mfma_f32_16x16x32_bf16 v[144:147], v[128:131], v[224:227], v[144:147]
    ds_read_b64_tr_b16 v[208:209], v16 offset:49152
    buffer_load_dwordx4 v[72:75], v8, s[8:11], s45 offen offset:2048 sc1
    v_mfma_f32_16x16x32_bf16 v[148:151], v[128:131], v[228:231], v[148:151]
    ds_read_b64_tr_b16 v[210:211], v16 offset:51200
    v_mfma_f32_16x16x32_bf16 v[152:155], v[128:131], v[232:235], v[152:155]
    ds_read_b64_tr_b16 v[212:213], v17 offset:49152
    v_mfma_f32_16x16x32_bf16 v[156:159], v[128:131], v[236:239], v[156:159]
    ds_read_b64_tr_b16 v[214:215], v17 offset:51200
    buffer_load_dwordx4 v[76:79], v8, s[8:11], s45 offen offset:3072 sc1
    v_mfma_f32_16x16x32_bf16 v[160:163], v[132:135], v[224:227], v[160:163]
    ds_read_b64_tr_b16 v[216:217], v18 offset:49152
    v_mfma_f32_16x16x32_bf16 v[164:167], v[132:135], v[228:231], v[164:167]
    ds_read_b64_tr_b16 v[218:219], v18 offset:51200
    v_mfma_f32_16x16x32_bf16 v[168:171], v[132:135], v[232:235], v[168:171]
    ds_read_b64_tr_b16 v[220:221], v19 offset:49152
    s_add_u32 s45, s45, 4096
    s_cmp_eq_u32 s45, s89
    s_cselect_b32 s45, s88, s45
    buffer_load_dwordx4 v[80:83], v8, s[8:11], s45 offen offset:0 sc1
    v_mfma_f32_16x16x32_bf16 v[172:175], v[132:135], v[236:239], v[172:175]
    ds_read_b64_tr_b16 v[222:223], v19 offset:51200
    v_mfma_f32_16x16x32_bf16 v[176:179], v[136:139], v[224:227], v[176:179]
    v_mfma_f32_16x16x32_bf16 v[180:183], v[136:139], v[228:231], v[180:183]
    buffer_load_dwordx4 v[84:87], v8, s[8:11], s45 offen offset:1024 sc1
    v_mfma_f32_16x16x32_bf16 v[184:187], v[136:139], v[232:235], v[184:187]
    v_mfma_f32_16x16x32_bf16 v[188:191], v[136:139], v[236:239], v[188:191]
    v_mfma_f32_16x16x32_bf16 v[192:195], v[140:143], v[224:227], v[192:195]
    buffer_load_dwordx4 v[88:91], v8, s[8:11], s45 offen offset:2048 sc1
    v_mfma_f32_16x16x32_bf16 v[196:199], v[140:143], v[228:231], v[196:199]
    v_mfma_f32_16x16x32_bf16 v[200:203], v[140:143], v[232:235], v[200:203]
    v_mfma_f32_16x16x32_bf16 v[204:207], v[140:143], v[236:239], v[204:207]
    buffer_load_dwordx4 v[92:95], v8, s[8:11], s45 offen offset:3072 sc1
    s_waitcnt vmcnt(63)
    s_waitcnt vmcnt(24) lgkmcnt(0)
    v_mfma_f32_16x16x32_bf16 v[144:147], v[208:211], v[240:243], v[144:147]
    ds_read_b64_tr_b16 v[224:225], v20 offset:0
    s_add_u32 s51, s51, 0x8000
    s_cmp_eq_u32 s51, s87
    s_cselect_b32 s51, s86, s51
    s_add_u32 m0, s52, 32768
    s_add_u32 s49, s51, 0
    buffer_load_dwordx4 v11, s[24:27], s49 offen lds
    v_mfma_f32_16x16x32_bf16 v[148:151], v[208:211], v[244:247], v[148:151]
    ds_read_b64_tr_b16 v[226:227], v20 offset:2048
    v_mfma_f32_16x16x32_bf16 v[152:155], v[208:211], v[248:251], v[152:155]
    ds_read_b64_tr_b16 v[228:229], v21 offset:0
    v_mfma_f32_16x16x32_bf16 v[156:159], v[208:211], v[252:255], v[156:159]
    ds_read_b64_tr_b16 v[230:231], v21 offset:2048
    buffer_load_dwordx4 v12, s[24:27], s49 offen offset:1024 lds
    v_mfma_f32_16x16x32_bf16 v[160:163], v[212:215], v[240:243], v[160:163]
    ds_read_b64_tr_b16 v[232:233], v22 offset:0
    v_mfma_f32_16x16x32_bf16 v[164:167], v[212:215], v[244:247], v[164:167]
    ds_read_b64_tr_b16 v[234:235], v22 offset:2048
    v_mfma_f32_16x16x32_bf16 v[168:171], v[212:215], v[248:251], v[168:171]
    ds_read_b64_tr_b16 v[236:237], v23 offset:0
    s_add_u32 m0, s52, 34816
    s_add_u32 s49, s51, 16384
    buffer_load_dwordx4 v11, s[24:27], s49 offen lds
    v_mfma_f32_16x16x32_bf16 v[172:175], v[212:215], v[252:255], v[172:175]
    ds_read_b64_tr_b16 v[238:239], v23 offset:2048
    v_mfma_f32_16x16x32_bf16 v[176:179], v[216:219], v[240:243], v[176:179]
    v_mfma_f32_16x16x32_bf16 v[180:183], v[216:219], v[244:247], v[180:183]
    buffer_load_dwordx4 v12, s[24:27], s49 offen offset:1024 lds
    v_mfma_f32_16x16x32_bf16 v[184:187], v[216:219], v[248:251], v[184:187]
    v_mfma_f32_16x16x32_bf16 v[188:191], v[216:219], v[252:255], v[188:191]
    v_mfma_f32_16x16x32_bf16 v[192:195], v[220:223], v[240:243], v[192:195]
    s_add_u32 s45, s45, 4096
    s_cmp_eq_u32 s45, s89
    s_cselect_b32 s45, s88, s45
    buffer_load_dwordx4 v[128:131], v8, s[8:11], s45 offen offset:0 sc1
    v_mfma_f32_16x16x32_bf16 v[196:199], v[220:223], v[244:247], v[196:199]
    v_mfma_f32_16x16x32_bf16 v[200:203], v[220:223], v[248:251], v[200:203]
    v_mfma_f32_16x16x32_bf16 v[204:207], v[220:223], v[252:255], v[204:207]
    buffer_load_dwordx4 v[132:135], v8, s[8:11], s45 offen offset:1024 sc1
    s_waitcnt vmcnt(63)
    s_waitcnt vmcnt(26) lgkmcnt(0)
    v_mfma_f32_16x16x32_bf16 v[144:147], v[224:227], v[32:35], v[144:147]
    ds_read_b64_tr_b16 v[240:241], v28 offset:32768
    s_add_u32 s51, s51, 0x8000
    s_cmp_eq_u32 s51, s87
    s_cselect_b32 s51, s86, s51
    s_add_u32 m0, s52, 49152
    s_add_u32 s49, s51, 0
    buffer_load_dwordx4 v11, s[24:27], s49 offen lds
    v_mfma_f32_16x16x32_bf16 v[148:151], v[224:227], v[36:39], v[148:151]
    ds_read_b64_tr_b16 v[242:243], v28 offset:34816
    v_mfma_f32_16x16x32_bf16 v[152:155], v[224:227], v[40:43], v[152:155]
    ds_read_b64_tr_b16 v[244:245], v29 offset:32768
    v_mfma_f32_16x16x32_bf16 v[156:159], v[224:227], v[44:47], v[156:159]
    ds_read_b64_tr_b16 v[246:247], v29 offset:34816
    buffer_load_dwordx4 v12, s[24:27], s49 offen offset:1024 lds
    v_mfma_f32_16x16x32_bf16 v[160:163], v[228:231], v[32:35], v[160:163]
    ds_read_b64_tr_b16 v[248:249], v30 offset:32768
    v_mfma_f32_16x16x32_bf16 v[164:167], v[228:231], v[36:39], v[164:167]
    ds_read_b64_tr_b16 v[250:251], v30 offset:34816
    v_mfma_f32_16x16x32_bf16 v[168:171], v[228:231], v[40:43], v[168:171]
    ds_read_b64_tr_b16 v[252:253], v31 offset:32768
    s_add_u32 m0, s52, 51200
    s_add_u32 s49, s51, 16384
    buffer_load_dwordx4 v11, s[24:27], s49 offen lds
    v_mfma_f32_16x16x32_bf16 v[172:175], v[228:231], v[44:47], v[172:175]
    ds_read_b64_tr_b16 v[254:255], v31 offset:34816
    v_mfma_f32_16x16x32_bf16 v[176:179], v[232:235], v[32:35], v[176:179]
    v_mfma_f32_16x16x32_bf16 v[180:183], v[232:235], v[36:39], v[180:183]
    buffer_load_dwordx4 v12, s[24:27], s49 offen offset:1024 lds
    v_mfma_f32_16x16x32_bf16 v[184:187], v[232:235], v[40:43], v[184:187]
    v_mfma_f32_16x16x32_bf16 v[188:191], v[232:235], v[44:47], v[188:191]
    v_mfma_f32_16x16x32_bf16 v[192:195], v[236:239], v[32:35], v[192:195]
    buffer_load_dwordx4 v[136:139], v8, s[8:11], s45 offen offset:2048 sc1
    v_mfma_f32_16x16x32_bf16 v[196:199], v[236:239], v[36:39], v[196:199]
    v_mfma_f32_16x16x32_bf16 v[200:203], v[236:239], v[40:43], v[200:203]
    v_mfma_f32_16x16x32_bf16 v[204:207], v[236:239], v[44:47], v[204:207]
    buffer_load_dwordx4 v[140:143], v8, s[8:11], s45 offen offset:3072 sc1
    s_waitcnt vmcnt(63)
    s_waitcnt vmcnt(28) lgkmcnt(0)
    v_mfma_f32_16x16x32_bf16 v[144:147], v[240:243], v[96:99], v[144:147]
    ds_read_b64_tr_b16 v[224:225], v28 offset:49152
    s_add_u32 s51, s51, 0x8000
    s_cmp_eq_u32 s51, s87
    s_cselect_b32 s51, s86, s51
    s_add_u32 m0, s52, 98304
    s_add_u32 s49, s51, 0
    buffer_load_dwordx4 v11, s[24:27], s49 offen lds
    v_mfma_f32_16x16x32_bf16 v[148:151], v[240:243], v[100:103], v[148:151]
    ds_read_b64_tr_b16 v[226:227], v28 offset:51200
    v_mfma_f32_16x16x32_bf16 v[152:155], v[240:243], v[104:107], v[152:155]
    ds_read_b64_tr_b16 v[228:229], v29 offset:49152
    v_mfma_f32_16x16x32_bf16 v[156:159], v[240:243], v[108:111], v[156:159]
    ds_read_b64_tr_b16 v[230:231], v29 offset:51200
    buffer_load_dwordx4 v12, s[24:27], s49 offen offset:1024 lds
    v_mfma_f32_16x16x32_bf16 v[160:163], v[244:247], v[96:99], v[160:163]
    ds_read_b64_tr_b16 v[232:233], v30 offset:49152
    v_mfma_f32_16x16x32_bf16 v[164:167], v[244:247], v[100:103], v[164:167]
    ds_read_b64_tr_b16 v[234:235], v30 offset:51200
    v_mfma_f32_16x16x32_bf16 v[168:171], v[244:247], v[104:107], v[168:171]
    ds_read_b64_tr_b16 v[236:237], v31 offset:49152
    s_add_u32 m0, s52, 100352
    s_add_u32 s49, s51, 16384
    buffer_load_dwordx4 v11, s[24:27], s49 offen lds
    v_mfma_f32_16x16x32_bf16 v[172:175], v[244:247], v[108:111], v[172:175]
    ds_read_b64_tr_b16 v[238:239], v31 offset:51200
    v_mfma_f32_16x16x32_bf16 v[176:179], v[248:251], v[96:99], v[176:179]
    v_mfma_f32_16x16x32_bf16 v[180:183], v[248:251], v[100:103], v[180:183]
    buffer_load_dwordx4 v12, s[24:27], s49 offen offset:1024 lds
    v_mfma_f32_16x16x32_bf16 v[184:187], v[248:251], v[104:107], v[184:187]
    v_mfma_f32_16x16x32_bf16 v[188:191], v[248:251], v[108:111], v[188:191]
    v_mfma_f32_16x16x32_bf16 v[192:195], v[252:255], v[96:99], v[192:195]
    s_add_u32 s45, s45, 4096
    s_cmp_eq_u32 s45, s89
    s_cselect_b32 s45, s88, s45
    buffer_load_dwordx4 v[208:211], v8, s[8:11], s45 offen offset:0 sc1
    v_mfma_f32_16x16x32_bf16 v[196:199], v[252:255], v[100:103], v[196:199]
    v_mfma_f32_16x16x32_bf16 v[200:203], v[252:255], v[104:107], v[200:203]
    v_mfma_f32_16x16x32_bf16 v[204:207], v[252:255], v[108:111], v[204:207]
    buffer_load_dwordx4 v[212:215], v8, s[8:11], s45 offen offset:1024 sc1
    s_waitcnt vmcnt(63)
    s_waitcnt vmcnt(30) lgkmcnt(0)
    v_mfma_f32_16x16x32_bf16 v[144:147], v[224:227], v[48:51], v[144:147]
    ds_read_b64_tr_b16 v[32:33], v16 offset:0
    buffer_load_dwordx4 v[216:219], v8, s[8:11], s45 offen offset:2048 sc1
    v_mfma_f32_16x16x32_bf16 v[148:151], v[224:227], v[52:55], v[148:151]
    ds_read_b64_tr_b16 v[34:35], v16 offset:2048
    v_mfma_f32_16x16x32_bf16 v[152:155], v[224:227], v[56:59], v[152:155]
    ds_read_b64_tr_b16 v[36:37], v17 offset:0
    v_mfma_f32_16x16x32_bf16 v[156:159], v[224:227], v[60:63], v[156:159]
    ds_read_b64_tr_b16 v[38:39], v17 offset:2048
    buffer_load_dwordx4 v[220:223], v8, s[8:11], s45 offen offset:3072 sc1
    v_mfma_f32_16x16x32_bf16 v[160:163], v[228:231], v[48:51], v[160:163]
    ds_read_b64_tr_b16 v[40:41], v18 offset:0
    v_mfma_f32_16x16x32_bf16 v[164:167], v[228:231], v[52:55], v[164:167]
    ds_read_b64_tr_b16 v[42:43], v18 offset:2048
    v_mfma_f32_16x16x32_bf16 v[168:171], v[228:231], v[56:59], v[168:171]
    ds_read_b64_tr_b16 v[44:45], v19 offset:0
    v_mfma_f32_16x16x32_bf16 v[172:175], v[228:231], v[60:63], v[172:175]
    ds_read_b64_tr_b16 v[46:47], v19 offset:2048
    v_mfma_f32_16x16x32_bf16 v[176:179], v[232:235], v[48:51], v[176:179]
    v_mfma_f32_16x16x32_bf16 v[180:183], v[232:235], v[52:55], v[180:183]
    v_mfma_f32_16x16x32_bf16 v[184:187], v[232:235], v[56:59], v[184:187]
    v_mfma_f32_16x16x32_bf16 v[188:191], v[232:235], v[60:63], v[188:191]
    v_mfma_f32_16x16x32_bf16 v[192:195], v[236:239], v[48:51], v[192:195]
    v_mfma_f32_16x16x32_bf16 v[196:199], v[236:239], v[52:55], v[196:199]
    v_mfma_f32_16x16x32_bf16 v[200:203], v[236:239], v[56:59], v[200:203]
    v_mfma_f32_16x16x32_bf16 v[204:207], v[236:239], v[60:63], v[204:207]
    v_mov_b32 v7, 1
    s_mov_b64 exec, 1
    ds_add_u32 v6, v7 offset:52
    s_mov_b64 exec, -1
    s_waitcnt vmcnt(63)
    s_waitcnt vmcnt(28) lgkmcnt(0)
    v_mfma_f32_16x16x32_bf16 v[144:147], v[32:35], v[112:115], v[144:147]
    ds_read_b64_tr_b16 v[240:241], v16 offset:16384
    v_mfma_f32_16x16x32_bf16 v[148:151], v[32:35], v[116:119], v[148:151]
    ds_read_b64_tr_b16 v[242:243], v16 offset:18432
    v_mfma_f32_16x16x32_bf16 v[152:155], v[32:35], v[120:123], v[152:155]
    ds_read_b64_tr_b16 v[244:245], v17 offset:16384
    v_mfma_f32_16x16x32_bf16 v[156:159], v[32:35], v[124:127], v[156:159]
    ds_read_b64_tr_b16 v[246:247], v17 offset:18432
    v_mfma_f32_16x16x32_bf16 v[160:163], v[36:39], v[112:115], v[160:163]
    ds_read_b64_tr_b16 v[248:249], v18 offset:16384
    v_mfma_f32_16x16x32_bf16 v[164:167], v[36:39], v[116:119], v[164:167]
    ds_read_b64_tr_b16 v[250:251], v18 offset:18432
    v_mfma_f32_16x16x32_bf16 v[168:171], v[36:39], v[120:123], v[168:171]
    ds_read_b64_tr_b16 v[252:253], v19 offset:16384
    v_mfma_f32_16x16x32_bf16 v[172:175], v[36:39], v[124:127], v[172:175]
    ds_read_b64_tr_b16 v[254:255], v19 offset:18432
    v_mfma_f32_16x16x32_bf16 v[176:179], v[40:43], v[112:115], v[176:179]
    v_mfma_f32_16x16x32_bf16 v[180:183], v[40:43], v[116:119], v[180:183]
    v_mfma_f32_16x16x32_bf16 v[184:187], v[40:43], v[120:123], v[184:187]
    v_mfma_f32_16x16x32_bf16 v[188:191], v[40:43], v[124:127], v[188:191]
    v_mfma_f32_16x16x32_bf16 v[192:195], v[44:47], v[112:115], v[192:195]
    v_mfma_f32_16x16x32_bf16 v[196:199], v[44:47], v[116:119], v[196:199]
    v_mfma_f32_16x16x32_bf16 v[200:203], v[44:47], v[120:123], v[200:203]
    v_mfma_f32_16x16x32_bf16 v[204:207], v[44:47], v[124:127], v[204:207]
    s_waitcnt vmcnt(16)
    s_waitcnt vmcnt(24) lgkmcnt(0)
    v_mfma_f32_16x16x32_bf16 v[144:147], v[240:243], v[64:67], v[144:147]
    ds_read_b64_tr_b16 v[96:97], v16 offset:32768
    v_mfma_f32_16x16x32_bf16 v[148:151], v[240:243], v[68:71], v[148:151]
    ds_read_b64_tr_b16 v[98:99], v16 offset:34816
    v_mfma_f32_16x16x32_bf16 v[152:155], v[240:243], v[72:75], v[152:155]
    ds_read_b64_tr_b16 v[100:101], v17 offset:32768
    v_mfma_f32_16x16x32_bf16 v[156:159], v[240:243], v[76:79], v[156:159]
    ds_read_b64_tr_b16 v[102:103], v17 offset:34816
    v_mfma_f32_16x16x32_bf16 v[160:163], v[244:247], v[64:67], v[160:163]
    ds_read_b64_tr_b16 v[104:105], v18 offset:32768
    v_mfma_f32_16x16x32_bf16 v[164:167], v[244:247], v[68:71], v[164:167]
    ds_read_b64_tr_b16 v[106:107], v18 offset:34816
    v_mfma_f32_16x16x32_bf16 v[168:171], v[244:247], v[72:75], v[168:171]
    ds_read_b64_tr_b16 v[108:109], v19 offset:32768
    v_mfma_f32_16x16x32_bf16 v[172:175], v[244:247], v[76:79], v[172:175]
    ds_read_b64_tr_b16 v[110:111], v19 offset:34816
    v_mfma_f32_16x16x32_bf16 v[176:179], v[248:251], v[64:67], v[176:179]
    v_mfma_f32_16x16x32_bf16 v[180:183], v[248:251], v[68:71], v[180:183]
    v_mfma_f32_16x16x32_bf16 v[184:187], v[248:251], v[72:75], v[184:187]
    v_mfma_f32_16x16x32_bf16 v[188:191], v[248:251], v[76:79], v[188:191]
    v_mfma_f32_16x16x32_bf16 v[192:195], v[252:255], v[64:67], v[192:195]
    v_mfma_f32_16x16x32_bf16 v[196:199], v[252:255], v[68:71], v[196:199]
    v_mfma_f32_16x16x32_bf16 v[200:203], v[252:255], v[72:75], v[200:203]
    v_mfma_f32_16x16x32_bf16 v[204:207], v[252:255], v[76:79], v[204:207]
    v_lshrrev_b32 v2, 3, v0
    v_lshlrev_b32 v9, 10, v2
    v_and_b32 v3, 7, v0
    v_lshl_add_u32 v9, v3, 4, v9
    s_lshl_b32 s55, s53, 16
    s_lshl_b32 s50, s54, 7
    s_add_u32 s55, s55, s50
    v_mul_u32_u24 v10, 272, v2
    v_lshl_add_u32 v10, v3, 5, v10
    v_add_u32 v10, 114688, v10
    v_and_b32 v4, 15, v2
    v_lshlrev_b32 v3, 1, v3
    v_xor_b32 v3, v3, v4
    v_lshlrev_b32 v3, 4, v3
    v_lshl_add_u32 v3, v4, 8, v3
    v_lshrrev_b32 v4, 4, v2
    v_lshl_add_u32 v14, v4, 14, v3
    v_xor_b32 v15, 16, v14
    v_lshlrev_b32 v2, 3, v2
    s_lshl_b32 s50, s53, 9
    s_add_u32 s50, s50, 7340032
    buffer_load_dwordx4 v[24:27], v9, s[12:15], s55 offen
    buffer_load_dwordx2 v[28:29], v2, s[8:11], s50 offen sc1
    s_waitcnt vmcnt(12)
    s_waitcnt vmcnt(22) lgkmcnt(0)
    v_mfma_f32_16x16x32_bf16 v[144:147], v[96:99], v[80:83], v[144:147]
    ds_read_b64_tr_b16 v[224:225], v16 offset:49152
    v_mfma_f32_16x16x32_bf16 v[148:151], v[96:99], v[84:87], v[148:151]
    ds_read_b64_tr_b16 v[226:227], v16 offset:51200
    v_mfma_f32_16x16x32_bf16 v[152:155], v[96:99], v[88:91], v[152:155]
    ds_read_b64_tr_b16 v[228:229], v17 offset:49152
    v_mfma_f32_16x16x32_bf16 v[156:159], v[96:99], v[92:95], v[156:159]
    ds_read_b64_tr_b16 v[230:231], v17 offset:51200
    v_mfma_f32_16x16x32_bf16 v[160:163], v[100:103], v[80:83], v[160:163]
    ds_read_b64_tr_b16 v[232:233], v18 offset:49152
    v_mfma_f32_16x16x32_bf16 v[164:167], v[100:103], v[84:87], v[164:167]
    ds_read_b64_tr_b16 v[234:235], v18 offset:51200
    v_mfma_f32_16x16x32_bf16 v[168:171], v[100:103], v[88:91], v[168:171]
    ds_read_b64_tr_b16 v[236:237], v19 offset:49152
    v_mfma_f32_16x16x32_bf16 v[172:175], v[100:103], v[92:95], v[172:175]
    ds_read_b64_tr_b16 v[238:239], v19 offset:51200
    v_mfma_f32_16x16x32_bf16 v[176:179], v[104:107], v[80:83], v[176:179]
    v_mfma_f32_16x16x32_bf16 v[180:183], v[104:107], v[84:87], v[180:183]
    v_mfma_f32_16x16x32_bf16 v[184:187], v[104:107], v[88:91], v[184:187]
    v_mfma_f32_16x16x32_bf16 v[188:191], v[104:107], v[92:95], v[188:191]
    v_mfma_f32_16x16x32_bf16 v[192:195], v[108:111], v[80:83], v[192:195]
    v_mfma_f32_16x16x32_bf16 v[196:199], v[108:111], v[84:87], v[196:199]
    v_mfma_f32_16x16x32_bf16 v[200:203], v[108:111], v[88:91], v[200:203]
    v_mfma_f32_16x16x32_bf16 v[204:207], v[108:111], v[92:95], v[204:207]
    s_waitcnt vmcnt(6)
    s_waitcnt vmcnt(10) lgkmcnt(0)
    v_mfma_f32_16x16x32_bf16 v[144:147], v[224:227], v[128:131], v[144:147]
    ds_read_b64_tr_b16 v[48:49], v20 offset:0
    ds_read_b64_tr_b16 v[50:51], v20 offset:2048
    v_mfma_f32_16x16x32_bf16 v[148:151], v[224:227], v[132:135], v[148:151]
    ds_read_b64_tr_b16 v[52:53], v21 offset:0
    ds_read_b64_tr_b16 v[54:55], v21 offset:2048
    v_mfma_f32_16x16x32_bf16 v[152:155], v[224:227], v[136:139], v[152:155]
    ds_read_b64_tr_b16 v[56:57], v22 offset:0
    ds_read_b64_tr_b16 v[58:59], v22 offset:2048
    v_mfma_f32_16x16x32_bf16 v[156:159], v[224:227], v[140:143], v[156:159]
    ds_read_b64_tr_b16 v[60:61], v23 offset:0
    ds_read_b64_tr_b16 v[62:63], v23 offset:2048
    v_mfma_f32_16x16x32_bf16 v[160:163], v[228:231], v[128:131], v[160:163]
    v_and_b32 v2, 15, v1
    v_lshrrev_b32 v3, 4, v1
    v_xor_b32 v3, v3, v2
    v_lshlrev_b32 v3, 4, v3
    v_mfma_f32_16x16x32_bf16 v[164:167], v[228:231], v[132:135], v[164:167]
    v_lshl_add_u32 v3, v2, 8, v3
    v_add_u32 v16, s52, v3
    v_xor_b32 v17, 64, v16
    v_xor_b32 v18, 128, v16
    v_mfma_f32_16x16x32_bf16 v[168:171], v[228:231], v[136:139], v[168:171]
    v_xor_b32 v19, 192, v16
    v_mfma_f32_16x16x32_bf16 v[172:175], v[228:231], v[140:143], v[172:175]
    s_waitcnt vmcnt(2) lgkmcnt(0)
    v_mfma_f32_16x16x32_bf16 v[144:147], v[48:51], v[208:211], v[144:147]
    s_nop 0
    v_mfma_f32_16x16x32_bf16 v[148:151], v[48:51], v[212:215], v[148:151]
    s_nop 0
    v_mfma_f32_16x16x32_bf16 v[152:155], v[48:51], v[216:219], v[152:155]
    s_nop 0
    v_mfma_f32_16x16x32_bf16 v[156:159], v[48:51], v[220:223], v[156:159]
    s_nop 0
    v_mfma_f32_16x16x32_bf16 v[160:163], v[52:55], v[208:211], v[160:163]
    s_nop 0
    v_mfma_f32_16x16x32_bf16 v[164:167], v[52:55], v[212:215], v[164:167]
    ds_write_b128 v16, v[144:147] offset:0
    v_mfma_f32_16x16x32_bf16 v[168:171], v[52:55], v[216:219], v[168:171]
    ds_write_b128 v16, v[148:151] offset:16384
    v_mfma_f32_16x16x32_bf16 v[172:175], v[52:55], v[220:223], v[172:175]
    ds_write_b128 v16, v[152:155] offset:32768
    v_mfma_f32_16x16x32_bf16 v[176:179], v[232:235], v[128:131], v[176:179]
    ds_write_b128 v16, v[156:159] offset:49152
    v_mfma_f32_16x16x32_bf16 v[180:183], v[232:235], v[132:135], v[180:183]
    ds_write_b128 v17, v[160:163] offset:0
    v_mfma_f32_16x16x32_bf16 v[184:187], v[232:235], v[136:139], v[184:187]
    ds_write_b128 v17, v[164:167] offset:16384
    v_mfma_f32_16x16x32_bf16 v[188:191], v[232:235], v[140:143], v[188:191]
    ds_write_b128 v17, v[168:171] offset:32768
    v_mfma_f32_16x16x32_bf16 v[192:195], v[236:239], v[128:131], v[192:195]
    ds_write_b128 v17, v[172:175] offset:49152
    v_mfma_f32_16x16x32_bf16 v[196:199], v[236:239], v[132:135], v[196:199]
    v_mfma_f32_16x16x32_bf16 v[200:203], v[236:239], v[136:139], v[200:203]
    v_mfma_f32_16x16x32_bf16 v[204:207], v[236:239], v[140:143], v[204:207]
    v_mfma_f32_16x16x32_bf16 v[176:179], v[56:59], v[208:211], v[176:179]
    v_mfma_f32_16x16x32_bf16 v[180:183], v[56:59], v[212:215], v[180:183]
    v_mfma_f32_16x16x32_bf16 v[184:187], v[56:59], v[216:219], v[184:187]
    s_nop 0
    v_mfma_f32_16x16x32_bf16 v[188:191], v[56:59], v[220:223], v[188:191]
    s_nop 0
    v_mfma_f32_16x16x32_bf16 v[192:195], v[60:63], v[208:211], v[192:195]
    s_nop 0
    v_mfma_f32_16x16x32_bf16 v[196:199], v[60:63], v[212:215], v[196:199]
    ds_write_b128 v18, v[176:179] offset:0
    v_mfma_f32_16x16x32_bf16 v[200:203], v[60:63], v[216:219], v[200:203]
    ds_write_b128 v18, v[180:183] offset:16384
    v_mfma_f32_16x16x32_bf16 v[204:207], v[60:63], v[220:223], v[204:207]
    ds_write_b128 v18, v[184:187] offset:32768
    ds_write_b128 v18, v[188:191] offset:49152
    s_nop 0
    ds_write_b128 v19, v[192:195] offset:0
    s_nop 0
    ds_write_b128 v19, v[196:199] offset:16384
    s_nop 0
    ds_write_b128 v19, v[200:203] offset:32768
    s_nop 0
    ds_write_b128 v19, v[204:207] offset:49152
F_fin:
    s_waitcnt vmcnt(0)
    v_and_b32 v28, 0xffff0000, v28
    v_rcp_f32 v29, v28
    s_nop 0
    v_fma_f32 v30, -v28, v29, 1.0
    v_fma_f32 v29, v30, v29, v29
    v_mul_f32 v28, v29, v29
    v_lshlrev_b32 v72, 16, v24
    v_and_b32 v73, 0xffff0000, v24
    v_lshlrev_b32 v74, 16, v25
    v_and_b32 v75, 0xffff0000, v25
    v_lshlrev_b32 v76, 16, v26
    v_and_b32 v77, 0xffff0000, v26
    v_lshlrev_b32 v78, 16, v27
    v_and_b32 v79, 0xffff0000, v27
    s_waitcnt lgkmcnt(0)
    s_barrier
    ds_read_b128 v[32:35], v14 offset:0
    ds_read_b128 v[36:39], v15 offset:0
    ds_read_b128 v[40:43], v14 offset:4096
    ds_read_b128 v[44:47], v15 offset:4096
    ds_read_b128 v[48:51], v14 offset:8192
    ds_read_b128 v[52:55], v15 offset:8192
    ds_read_b128 v[56:59], v14 offset:12288
    ds_read_b128 v[60:63], v15 offset:12288
    ds_read_b128 v[64:67], v10 offset:0
    ds_read_b128 v[68:71], v10 offset:16
    s_waitcnt lgkmcnt(6)
    v_pk_add_f32 v[32:33], v[32:33], v[40:41]
    v_pk_add_f32 v[34:35], v[34:35], v[42:43]
    v_pk_add_f32 v[36:37], v[36:37], v[44:45]
    v_pk_add_f32 v[38:39], v[38:39], v[46:47]
    s_waitcnt lgkmcnt(4)
    v_pk_add_f32 v[32:33], v[32:33], v[48:49]
    v_pk_add_f32 v[34:35], v[34:35], v[50:51]
    v_pk_add_f32 v[36:37], v[36:37], v[52:53]
    v_pk_add_f32 v[38:39], v[38:39], v[54:55]
    s_waitcnt lgkmcnt(2)
    v_pk_add_f32 v[32:33], v[32:33], v[56:57]
    v_pk_add_f32 v[34:35], v[34:35], v[58:59]
    v_pk_add_f32 v[36:37], v[36:37], v[60:61]
    v_pk_add_f32 v[38:39], v[38:39], v[62:63]
    v_pk_fma_f32 v[32:33], v[32:33], v[28:29], v[72:73] op_sel_hi:[1,0,1]
    v_pk_fma_f32 v[34:35], v[34:35], v[28:29], v[74:75] op_sel_hi:[1,0,1]
    v_pk_fma_f32 v[36:37], v[36:37], v[28:29], v[76:77] op_sel_hi:[1,0,1]
    v_pk_fma_f32 v[38:39], v[38:39], v[28:29], v[78:79] op_sel_hi:[1,0,1]
    s_waitcnt lgkmcnt(0)
    v_pk_add_f32 v[32:33], v[32:33], v[64:65]
    v_pk_add_f32 v[34:35], v[34:35], v[66:67]
    v_pk_add_f32 v[36:37], v[36:37], v[68:69]
    v_pk_add_f32 v[38:39], v[38:39], v[70:71]
    v_cvt_pk_bf16_f32 v24, v32, v33
    v_cvt_pk_bf16_f32 v25, v34, v35
    v_cvt_pk_bf16_f32 v26, v36, v37
    v_cvt_pk_bf16_f32 v27, v38, v39
    buffer_store_dwordx4 v[24:27], v9, s[28:31], s55 offen
F_end:
    s_endpgm
F_aux:
    s_memrealtime s[40:41]
    v_mov_b32 v6, 163328
    v_mov_b32 v7, 1
    v_mov_b32 v15, 0
    s_setprio 0
    s_cmp_ge_u32 s4, 4
    s_cbranch_scc1 F_aux2
    s_setprio 2
    v_lshlrev_b32 v2, 4, v1
    s_lshl_b32 s44, s2, 6
    s_lshl_b32 s45, s4, 4
    s_add_u32 s44, s44, s45
    s_lshl_b32 s42, s44, 10
    s_waitcnt lgkmcnt(0)
    buffer_load_dwordx4 v[16:19], v2, s[12:15], s42 offen offset:0
    buffer_load_dwordx4 v[20:23], v2, s[12:15], s42 offen offset:1024
    buffer_load_dwordx4 v[24:27], v2, s[12:15], s42 offen offset:2048
    buffer_load_dwordx4 v[28:31], v2, s[12:15], s42 offen offset:3072
    s_add_u32 s42, s42, 4096
    buffer_load_dwordx4 v[32:35], v2, s[12:15], s42 offen offset:0
    buffer_load_dwordx4 v[36:39], v2, s[12:15], s42 offen offset:1024
    buffer_load_dwordx4 v[40:43], v2, s[12:15], s42 offen offset:2048
    buffer_load_dwordx4 v[44:47], v2, s[12:15], s42 offen offset:3072
    s_add_u32 s42, s42, 4096
    buffer_load_dwordx4 v[48:51], v2, s[12:15], s42 offen offset:0
    buffer_load_dwordx4 v[52:55], v2, s[12:15], s42 offen offset:1024
    buffer_load_dwordx4 v[56:59], v2, s[12:15], s42 offen offset:2048
    buffer_load_dwordx4 v[60:63], v2, s[12:15], s42 offen offset:3072
    s_add_u32 s42, s42, 4096
    buffer_load_dwordx4 v[64:67], v2, s[12:15], s42 offen offset:0
    buffer_load_dwordx4 v[68:71], v2, s[12:15], s42 offen offset:1024
    buffer_load_dwordx4 v[72:75], v2, s[12:15], s42 offen offset:2048
    buffer_load_dwordx4 v[76:79], v2, s[12:15], s42 offen offset:3072
    s_load_dwordx2 s[8:9], s[0:1], 104
    s_load_dwordx2 s[32:33], s[0:1], 96
    s_load_dwordx2 s[24:25], s[0:1], 80
    s_load_dwordx2 s[28:29], s[0:1], 88
    s_mov_b32 s10, 0x10000000
    s_mov_b32 s11, 0x20000
    s_mov_b32 s34, 0x100
    s_mov_b32 s35, 0x20000
    s_mov_b32 s26, 0x1c0000
    s_mov_b32 s27, 0x20000
    s_mov_b32 s30, 0x200000
    s_mov_b32 s31, 0x20000
    s_and_b32 s53, s2, 7
    s_lshl_b32 s53, s53, 2
    s_lshr_b32 s40, s2, 6
    s_add_u32 s53, s53, s40
    s_bfe_u32 s54, s2, 0x30003
    s_lshl_b32 s40, s2, 2
    s_waitcnt lgkmcnt(0)
    s_load_dword s63, s[74:75], s40
    s_lshl_b32 s46, s4, 1
    v_and_b32 v9, 7, v1
    v_xor_b32 v9, s46, v9
    v_lshlrev_b32 v9, 4, v9
    v_lshl_add_u32 v9, v1, 10, v9
    v_xor_b32 v10, 16, v9
    s_barrier
    ds_read_b32 v13, v6 offset:256
    s_waitcnt vmcnt(15)
    v_lshlrev_b32 v80, 16, v16
    v_and_b32 v81, 0xffff0000, v16
    v_lshlrev_b32 v82, 16, v17
    v_and_b32 v83, 0xffff0000, v17
    v_lshlrev_b32 v84, 16, v18
    v_and_b32 v85, 0xffff0000, v18
    v_lshlrev_b32 v86, 16, v19
    v_and_b32 v87, 0xffff0000, v19
    v_pk_add_f32 v[224:225], v[80:81], v[82:83]
    v_pk_add_f32 v[226:227], v[84:85], v[86:87]
    v_pk_add_f32 v[224:225], v[224:225], v[226:227]
    v_add_f32 v208, v224, v225
    s_waitcnt vmcnt(14)
    v_lshlrev_b32 v88, 16, v20
    v_and_b32 v89, 0xffff0000, v20
    v_lshlrev_b32 v90, 16, v21
    v_and_b32 v91, 0xffff0000, v21
    v_lshlrev_b32 v92, 16, v22
    v_and_b32 v93, 0xffff0000, v22
    v_lshlrev_b32 v94, 16, v23
    v_and_b32 v95, 0xffff0000, v23
    v_pk_add_f32 v[224:225], v[88:89], v[90:91]
    v_pk_add_f32 v[226:227], v[92:93], v[94:95]
    v_pk_add_f32 v[224:225], v[224:225], v[226:227]
    v_add_f32 v209, v224, v225
    s_waitcnt vmcnt(13)
    v_lshlrev_b32 v96, 16, v24
    v_and_b32 v97, 0xffff0000, v24
    v_lshlrev_b32 v98, 16, v25
    v_and_b32 v99, 0xffff0000, v25
    v_lshlrev_b32 v100, 16, v26
    v_and_b32 v101, 0xffff0000, v26
    v_lshlrev_b32 v102, 16, v27
    v_and_b32 v103, 0xffff0000, v27
    v_pk_add_f32 v[224:225], v[96:97], v[98:99]
    v_pk_add_f32 v[226:227], v[100:101], v[102:103]
    v_pk_add_f32 v[224:225], v[224:225], v[226:227]
    v_add_f32 v210, v224, v225
    s_waitcnt vmcnt(12)
    v_lshlrev_b32 v104, 16, v28
    v_and_b32 v105, 0xffff0000, v28
    v_lshlrev_b32 v106, 16, v29
    v_and_b32 v107, 0xffff0000, v29
    v_lshlrev_b32 v108, 16, v30
    v_and_b32 v109, 0xffff0000, v30
    v_lshlrev_b32 v110, 16, v31
    v_and_b32 v111, 0xffff0000, v31
    v_pk_add_f32 v[224:225], v[104:105], v[106:107]
    v_pk_add_f32 v[226:227], v[108:109], v[110:111]
    v_pk_add_f32 v[224:225], v[224:225], v[226:227]
    v_add_f32 v211, v224, v225
    s_waitcnt vmcnt(11)
    v_lshlrev_b32 v112, 16, v32
    v_and_b32 v113, 0xffff0000, v32
    v_lshlrev_b32 v114, 16, v33
    v_and_b32 v115, 0xffff0000, v33
    v_lshlrev_b32 v116, 16, v34
    v_and_b32 v117, 0xffff0000, v34
    v_lshlrev_b32 v118, 16, v35
    v_and_b32 v119, 0xffff0000, v35
    v_pk_add_f32 v[224:225], v[112:113], v[114:115]
    v_pk_add_f32 v[226:227], v[116:117], v[118:119]
    v_pk_add_f32 v[224:225], v[224:225], v[226:227]
    v_add_f32 v212, v224, v225
    s_waitcnt vmcnt(10)
    v_lshlrev_b32 v120, 16, v36
    v_and_b32 v121, 0xffff0000, v36
    v_lshlrev_b32 v122, 16, v37
    v_and_b32 v123, 0xffff0000, v37
    v_lshlrev_b32 v124, 16, v38
    v_and_b32 v125, 0xffff0000, v38
    v_lshlrev_b32 v126, 16, v39
    v_and_b32 v127, 0xffff0000, v39
    v_pk_add_f32 v[224:225], v[120:121], v[122:123]
    v_pk_add_f32 v[226:227], v[124:125], v[126:127]
    v_pk_add_f32 v[224:225], v[224:225], v[226:227]
    v_add_f32 v213, v224, v225
    s_waitcnt vmcnt(9)
    v_lshlrev_b32 v128, 16, v40
    v_and_b32 v129, 0xffff0000, v40
    v_lshlrev_b32 v130, 16, v41
    v_and_b32 v131, 0xffff0000, v41
    v_lshlrev_b32 v132, 16, v42
    v_and_b32 v133, 0xffff0000, v42
    v_lshlrev_b32 v134, 16, v43
    v_and_b32 v135, 0xffff0000, v43
    v_pk_add_f32 v[224:225], v[128:129], v[130:131]
    v_pk_add_f32 v[226:227], v[132:133], v[134:135]
    v_pk_add_f32 v[224:225], v[224:225], v[226:227]
    v_add_f32 v214, v224, v225
    s_waitcnt vmcnt(8)
    v_lshlrev_b32 v136, 16, v44
    v_and_b32 v137, 0xffff0000, v44
    v_lshlrev_b32 v138, 16, v45
    v_and_b32 v139, 0xffff0000, v45
    v_lshlrev_b32 v140, 16, v46
    v_and_b32 v141, 0xffff0000, v46
    v_lshlrev_b32 v142, 16, v47
    v_and_b32 v143, 0xffff0000, v47
    v_pk_add_f32 v[224:225], v[136:137], v[138:139]
    v_pk_add_f32 v[226:227], v[140:141], v[142:143]
    v_pk_add_f32 v[224:225], v[224:225], v[226:227]
    v_add_f32 v215, v224, v225
    s_waitcnt vmcnt(7)
    v_lshlrev_b32 v144, 16, v48
    v_and_b32 v145, 0xffff0000, v48
    v_lshlrev_b32 v146, 16, v49
    v_and_b32 v147, 0xffff0000, v49
    v_lshlrev_b32 v148, 16, v50
    v_and_b32 v149, 0xffff0000, v50
    v_lshlrev_b32 v150, 16, v51
    v_and_b32 v151, 0xffff0000, v51
    v_pk_add_f32 v[224:225], v[144:145], v[146:147]
    v_pk_add_f32 v[226:227], v[148:149], v[150:151]
    v_pk_add_f32 v[224:225], v[224:225], v[226:227]
    v_add_f32 v216, v224, v225
    s_waitcnt vmcnt(6)
    v_lshlrev_b32 v152, 16, v52
    v_and_b32 v153, 0xffff0000, v52
    v_lshlrev_b32 v154, 16, v53
    v_and_b32 v155, 0xffff0000, v53
    v_lshlrev_b32 v156, 16, v54
    v_and_b32 v157, 0xffff0000, v54
    v_lshlrev_b32 v158, 16, v55
    v_and_b32 v159, 0xffff0000, v55
    v_pk_add_f32 v[224:225], v[152:153], v[154:155]
    v_pk_add_f32 v[226:227], v[156:157], v[158:159]
    v_pk_add_f32 v[224:225], v[224:225], v[226:227]
    v_add_f32 v217, v224, v225
    s_waitcnt vmcnt(5)
    v_lshlrev_b32 v160, 16, v56
    v_and_b32 v161, 0xffff0000, v56
    v_lshlrev_b32 v162, 16, v57
    v_and_b32 v163, 0xffff0000, v57
    v_lshlrev_b32 v164, 16, v58
    v_and_b32 v165, 0xffff0000, v58
    v_lshlrev_b32 v166, 16, v59
    v_and_b32 v167, 0xffff0000, v59
    v_pk_add_f32 v[224:225], v[160:161], v[162:163]
    v_pk_add_f32 v[226:227], v[164:165], v[166:167]
    v_pk_add_f32 v[224:225], v[224:225], v[226:227]
    v_add_f32 v218, v224, v225
    s_waitcnt vmcnt(4)
    v_lshlrev_b32 v168, 16, v60
    v_and_b32 v169, 0xffff0000, v60
    v_lshlrev_b32 v170, 16, v61
    v_and_b32 v171, 0xffff0000, v61
    v_lshlrev_b32 v172, 16, v62
    v_and_b32 v173, 0xffff0000, v62
    v_lshlrev_b32 v174, 16, v63
    v_and_b32 v175, 0xffff0000, v63
    v_pk_add_f32 v[224:225], v[168:169], v[170:171]
    v_pk_add_f32 v[226:227], v[172:173], v[174:175]
    v_pk_add_f32 v[224:225], v[224:225], v[226:227]
    v_add_f32 v219, v224, v225
    s_waitcnt vmcnt(3)
    v_lshlrev_b32 v176, 16, v64
    v_and_b32 v177, 0xffff0000, v64
    v_lshlrev_b32 v178, 16, v65
    v_and_b32 v179, 0xffff0000, v65
    v_lshlrev_b32 v180, 16, v66
    v_and_b32 v181, 0xffff0000, v66
    v_lshlrev_b32 v182, 16, v67
    v_and_b32 v183, 0xffff0000, v67
    v_pk_add_f32 v[224:225], v[176:177], v[178:179]
    v_pk_add_f32 v[226:227], v[180:181], v[182:183]
    v_pk_add_f32 v[224:225], v[224:225], v[226:227]
    v_add_f32 v220, v224, v225
    s_waitcnt vmcnt(2)
    v_lshlrev_b32 v184, 16, v68
    v_and_b32 v185, 0xffff0000, v68
    v_lshlrev_b32 v186, 16, v69
    v_and_b32 v187, 0xffff0000, v69
    v_lshlrev_b32 v188, 16, v70
    v_and_b32 v189, 0xffff0000, v70
    v_lshlrev_b32 v190, 16, v71
    v_and_b32 v191, 0xffff0000, v71
    v_pk_add_f32 v[224:225], v[184:185], v[186:187]
    v_pk_add_f32 v[226:227], v[188:189], v[190:191]
    v_pk_add_f32 v[224:225], v[224:225], v[226:227]
    v_add_f32 v221, v224, v225
    s_waitcnt vmcnt(1)
    v_lshlrev_b32 v192, 16, v72
    v_and_b32 v193, 0xffff0000, v72
    v_lshlrev_b32 v194, 16, v73
    v_and_b32 v195, 0xffff0000, v73
    v_lshlrev_b32 v196, 16, v74
    v_and_b32 v197, 0xffff0000, v74
    v_lshlrev_b32 v198, 16, v75
    v_and_b32 v199, 0xffff0000, v75
    v_pk_add_f32 v[224:225], v[192:193], v[194:195]
    v_pk_add_f32 v[226:227], v[196:197], v[198:199]
    v_pk_add_f32 v[224:225], v[224:225], v[226:227]
    v_add_f32 v222, v224, v225
    s_waitcnt vmcnt(0)
    v_lshlrev_b32 v200, 16, v76
    v_and_b32 v201, 0xffff0000, v76
    v_lshlrev_b32 v202, 16, v77
    v_and_b32 v203, 0xffff0000, v77
    v_lshlrev_b32 v204, 16, v78
    v_and_b32 v205, 0xffff0000, v78
    v_lshlrev_b32 v206, 16, v79
    v_and_b32 v207, 0xffff0000, v79
    v_pk_add_f32 v[224:225], v[200:201], v[202:203]
    v_pk_add_f32 v[226:227], v[204:205], v[206:207]
    v_pk_add_f32 v[224:225], v[224:225], v[226:227]
    v_add_f32 v223, v224, v225
    v_permlane32_swap_b32 v208, v216
    v_permlane32_swap_b32 v209, v217
    v_permlane32_swap_b32 v210, v218
    v_permlane32_swap_b32 v211, v219
    v_permlane32_swap_b32 v212, v220
    v_permlane32_swap_b32 v213, v221
    v_permlane32_swap_b32 v214, v222
    v_permlane32_swap_b32 v215, v223
    v_add_f32 v208, v208, v216
    v_add_f32 v209, v209, v217
    v_add_f32 v210, v210, v218
    v_add_f32 v211, v211, v219
    v_add_f32 v212, v212, v220
    v_add_f32 v213, v213, v221
    v_add_f32 v214, v214, v222
    v_add_f32 v215, v215, v223
    v_permlane16_swap_b32 v208, v212
    v_permlane16_swap_b32 v209, v213
    v_permlane16_swap_b32 v210, v214
    v_permlane16_swap_b32 v211, v215
    v_add_f32 v208, v208, v212
    v_add_f32 v209, v209, v213
    v_add_f32 v210, v210, v214
    v_add_f32 v211, v211, v215
    s_nop 0
    v_add_f32_dpp v224, v208, v208 row_ror:8 row_mask:0xf bank_mask:0x3
    v_add_f32_dpp v225, v209, v209 row_ror:8 row_mask:0xf bank_mask:0x3
    s_nop 0
    v_add_f32_dpp v224, v210, v210 row_ror:8 row_mask:0xf bank_mask:0xc
    v_add_f32_dpp v225, v211, v211 row_ror:8 row_mask:0xf bank_mask:0xc
    s_nop 0
    v_add_f32_dpp v208, v224, v224 row_half_mirror row_mask:0xf bank_mask:0x5
    s_nop 1
    v_add_f32_dpp v208, v225, v225 row_half_mirror row_mask:0xf bank_mask:0xa
    s_nop 1
    v_add_f32_dpp v208, v208, v208 quad_perm:[1,0,3,2] row_mask:0xf bank_mask:0xf
    s_nop 1
    v_add_f32_dpp v208, v208, v208 quad_perm:[2,3,0,1] row_mask:0xf bank_mask:0xf
    v_mul_f32 v224, 0x3b000000, v208
    v_cvt_pk_bf16_f32 v228, v224, v224
    v_and_b32 v228, 0xffff0000, v228
    v_sub_f32 v229, v224, v228
    v_readlane_b32 s76, v228, 0
    v_readlane_b32 s77, v228, 4
    v_readlane_b32 s78, v228, 8
    v_readlane_b32 s79, v228, 12
    v_readlane_b32 s80, v228, 16
    v_readlane_b32 s81, v228, 20
    v_readlane_b32 s82, v228, 24
    v_readlane_b32 s83, v228, 28
    v_readlane_b32 s84, v228, 32
    v_readlane_b32 s85, v228, 36
    v_readlane_b32 s86, v228, 40
    v_readlane_b32 s87, v228, 44
    v_readlane_b32 s88, v228, 48
    v_readlane_b32 s89, v228, 52
    v_readlane_b32 s90, v228, 56
    v_readlane_b32 s91, v228, 60
    v_pk_add_f32 v[80:81], v[80:81], s[76:77] op_sel:[0,0] op_sel_hi:[1,0] neg_lo:[0,1] neg_hi:[0,1]
    v_pk_add_f32 v[82:83], v[82:83], s[76:77] op_sel:[0,0] op_sel_hi:[1,0] neg_lo:[0,1] neg_hi:[0,1]
    v_pk_add_f32 v[84:85], v[84:85], s[76:77] op_sel:[0,0] op_sel_hi:[1,0] neg_lo:[0,1] neg_hi:[0,1]
    v_pk_add_f32 v[86:87], v[86:87], s[76:77] op_sel:[0,0] op_sel_hi:[1,0] neg_lo:[0,1] neg_hi:[0,1]
    v_pk_mul_f32 v[224:225], v[80:81], v[80:81]
    v_pk_fma_f32 v[224:225], v[82:83], v[82:83], v[224:225]
    v_pk_fma_f32 v[224:225], v[84:85], v[84:85], v[224:225]
    v_pk_fma_f32 v[224:225], v[86:87], v[86:87], v[224:225]
    v_add_f32 v208, v224, v225
    v_pk_add_f32 v[88:89], v[88:89], s[76:77] op_sel:[0,1] op_sel_hi:[1,1] neg_lo:[0,1] neg_hi:[0,1]
    v_pk_add_f32 v[90:91], v[90:91], s[76:77] op_sel:[0,1] op_sel_hi:[1,1] neg_lo:[0,1] neg_hi:[0,1]
    v_pk_add_f32 v[92:93], v[92:93], s[76:77] op_sel:[0,1] op_sel_hi:[1,1] neg_lo:[0,1] neg_hi:[0,1]
    v_pk_add_f32 v[94:95], v[94:95], s[76:77] op_sel:[0,1] op_sel_hi:[1,1] neg_lo:[0,1] neg_hi:[0,1]
    v_pk_mul_f32 v[224:225], v[88:89], v[88:89]
    v_pk_fma_f32 v[224:225], v[90:91], v[90:91], v[224:225]
    v_pk_fma_f32 v[224:225], v[92:93], v[92:93], v[224:225]
    v_pk_fma_f32 v[224:225], v[94:95], v[94:95], v[224:225]
    v_add_f32 v209, v224, v225
    v_pk_add_f32 v[96:97], v[96:97], s[78:79] op_sel:[0,0] op_sel_hi:[1,0] neg_lo:[0,1] neg_hi:[0,1]
    v_pk_add_f32 v[98:99], v[98:99], s[78:79] op_sel:[0,0] op_sel_hi:[1,0] neg_lo:[0,1] neg_hi:[0,1]
    v_pk_add_f32 v[100:101], v[100:101], s[78:79] op_sel:[0,0] op_sel_hi:[1,0] neg_lo:[0,1] neg_hi:[0,1]
    v_pk_add_f32 v[102:103], v[102:103], s[78:79] op_sel:[0,0] op_sel_hi:[1,0] neg_lo:[0,1] neg_hi:[0,1]
    v_pk_mul_f32 v[224:225], v[96:97], v[96:97]
    v_pk_fma_f32 v[224:225], v[98:99], v[98:99], v[224:225]
    v_pk_fma_f32 v[224:225], v[100:101], v[100:101], v[224:225]
    v_pk_fma_f32 v[224:225], v[102:103], v[102:103], v[224:225]
    v_add_f32 v210, v224, v225
    v_pk_add_f32 v[104:105], v[104:105], s[78:79] op_sel:[0,1] op_sel_hi:[1,1] neg_lo:[0,1] neg_hi:[0,1]
    v_pk_add_f32 v[106:107], v[106:107], s[78:79] op_sel:[0,1] op_sel_hi:[1,1] neg_lo:[0,1] neg_hi:[0,1]
    v_pk_add_f32 v[108:109], v[108:109], s[78:79] op_sel:[0,1] op_sel_hi:[1,1] neg_lo:[0,1] neg_hi:[0,1]
    v_pk_add_f32 v[110:111], v[110:111], s[78:79] op_sel:[0,1] op_sel_hi:[1,1] neg_lo:[0,1] neg_hi:[0,1]
    v_pk_mul_f32 v[224:225], v[104:105], v[104:105]
    v_pk_fma_f32 v[224:225], v[106:107], v[106:107], v[224:225]
    v_pk_fma_f32 v[224:225], v[108:109], v[108:109], v[224:225]
    v_pk_fma_f32 v[224:225], v[110:111], v[110:111], v[224:225]
    v_add_f32 v211, v224, v225
    v_pk_add_f32 v[112:113], v[112:113], s[80:81] op_sel:[0,0] op_sel_hi:[1,0] neg_lo:[0,1] neg_hi:[0,1]
    v_pk_add_f32 v[114:115], v[114:115], s[80:81] op_sel:[0,0] op_sel_hi:[1,0] neg_lo:[0,1] neg_hi:[0,1]
    v_pk_add_f32 v[116:117], v[116:117], s[80:81] op_sel:[0,0] op_sel_hi:[1,0] neg_lo:[0,1] neg_hi:[0,1]
    v_pk_add_f32 v[118:119], v[118:119], s[80:81] op_sel:[0,0] op_sel_hi:[1,0] neg_lo:[0,1] neg_hi:[0,1]
    v_pk_mul_f32 v[224:225], v[112:113], v[112:113]
    v_pk_fma_f32 v[224:225], v[114:115], v[114:115], v[224:225]
    v_pk_fma_f32 v[224:225], v[116:117], v[116:117], v[224:225]
    v_pk_fma_f32 v[224:225], v[118:119], v[118:119], v[224:225]
    v_add_f32 v212, v224, v225
    v_pk_add_f32 v[120:121], v[120:121], s[80:81] op_sel:[0,1] op_sel_hi:[1,1] neg_lo:[0,1] neg_hi:[0,1]
    v_pk_add_f32 v[122:123], v[122:123], s[80:81] op_sel:[0,1] op_sel_hi:[1,1] neg_lo:[0,1] neg_hi:[0,1]
    v_pk_add_f32 v[124:125], v[124:125], s[80:81] op_sel:[0,1] op_sel_hi:[1,1] neg_lo:[0,1] neg_hi:[0,1]
    v_pk_add_f32 v[126:127], v[126:127], s[80:81] op_sel:[0,1] op_sel_hi:[1,1] neg_lo:[0,1] neg_hi:[0,1]
    v_pk_mul_f32 v[224:225], v[120:121], v[120:121]
    v_pk_fma_f32 v[224:225], v[122:123], v[122:123], v[224:225]
    v_pk_fma_f32 v[224:225], v[124:125], v[124:125], v[224:225]
    v_pk_fma_f32 v[224:225], v[126:127], v[126:127], v[224:225]
    v_add_f32 v213, v224, v225
    v_pk_add_f32 v[128:129], v[128:129], s[82:83] op_sel:[0,0] op_sel_hi:[1,0] neg_lo:[0,1] neg_hi:[0,1]
    v_pk_add_f32 v[130:131], v[130:131], s[82:83] op_sel:[0,0] op_sel_hi:[1,0] neg_lo:[0,1] neg_hi:[0,1]
    v_pk_add_f32 v[132:133], v[132:133], s[82:83] op_sel:[0,0] op_sel_hi:[1,0] neg_lo:[0,1] neg_hi:[0,1]
    v_pk_add_f32 v[134:135], v[134:135], s[82:83] op_sel:[0,0] op_sel_hi:[1,0] neg_lo:[0,1] neg_hi:[0,1]
    v_pk_mul_f32 v[224:225], v[128:129], v[128:129]
    v_pk_fma_f32 v[224:225], v[130:131], v[130:131], v[224:225]
    v_pk_fma_f32 v[224:225], v[132:133], v[132:133], v[224:225]
    v_pk_fma_f32 v[224:225], v[134:135], v[134:135], v[224:225]
    v_add_f32 v214, v224, v225
    v_pk_add_f32 v[136:137], v[136:137], s[82:83] op_sel:[0,1] op_sel_hi:[1,1] neg_lo:[0,1] neg_hi:[0,1]
    v_pk_add_f32 v[138:139], v[138:139], s[82:83] op_sel:[0,1] op_sel_hi:[1,1] neg_lo:[0,1] neg_hi:[0,1]
    v_pk_add_f32 v[140:141], v[140:141], s[82:83] op_sel:[0,1] op_sel_hi:[1,1] neg_lo:[0,1] neg_hi:[0,1]
    v_pk_add_f32 v[142:143], v[142:143], s[82:83] op_sel:[0,1] op_sel_hi:[1,1] neg_lo:[0,1] neg_hi:[0,1]
    v_pk_mul_f32 v[224:225], v[136:137], v[136:137]
    v_pk_fma_f32 v[224:225], v[138:139], v[138:139], v[224:225]
    v_pk_fma_f32 v[224:225], v[140:141], v[140:141], v[224:225]
    v_pk_fma_f32 v[224:225], v[142:143], v[142:143], v[224:225]
    v_add_f32 v215, v224, v225
    v_pk_add_f32 v[144:145], v[144:145], s[84:85] op_sel:[0,0] op_sel_hi:[1,0] neg_lo:[0,1] neg_hi:[0,1]
    v_pk_add_f32 v[146:147], v[146:147], s[84:85] op_sel:[0,0] op_sel_hi:[1,0] neg_lo:[0,1] neg_hi:[0,1]
    v_pk_add_f32 v[148:149], v[148:149], s[84:85] op_sel:[0,0] op_sel_hi:[1,0] neg_lo:[0,1] neg_hi:[0,1]
    v_pk_add_f32 v[150:151], v[150:151], s[84:85] op_sel:[0,0] op_sel_hi:[1,0] neg_lo:[0,1] neg_hi:[0,1]
    v_pk_mul_f32 v[224:225], v[144:145], v[144:145]
    v_pk_fma_f32 v[224:225], v[146:147], v[146:147], v[224:225]
    v_pk_fma_f32 v[224:225], v[148:149], v[148:149], v[224:225]
    v_pk_fma_f32 v[224:225], v[150:151], v[150:151], v[224:225]
    v_add_f32 v216, v224, v225
    v_pk_add_f32 v[152:153], v[152:153], s[84:85] op_sel:[0,1] op_sel_hi:[1,1] neg_lo:[0,1] neg_hi:[0,1]
    v_pk_add_f32 v[154:155], v[154:155], s[84:85] op_sel:[0,1] op_sel_hi:[1,1] neg_lo:[0,1] neg_hi:[0,1]
    v_pk_add_f32 v[156:157], v[156:157], s[84:85] op_sel:[0,1] op_sel_hi:[1,1] neg_lo:[0,1] neg_hi:[0,1]
    v_pk_add_f32 v[158:159], v[158:159], s[84:85] op_sel:[0,1] op_sel_hi:[1,1] neg_lo:[0,1] neg_hi:[0,1]
    v_pk_mul_f32 v[224:225], v[152:153], v[152:153]
    v_pk_fma_f32 v[224:225], v[154:155], v[154:155], v[224:225]
    v_pk_fma_f32 v[224:225], v[156:157], v[156:157], v[224:225]
    v_pk_fma_f32 v[224:225], v[158:159], v[158:159], v[224:225]
    v_add_f32 v217, v224, v225
    v_pk_add_f32 v[160:161], v[160:161], s[86:87] op_sel:[0,0] op_sel_hi:[1,0] neg_lo:[0,1] neg_hi:[0,1]
    v_pk_add_f32 v[162:163], v[162:163], s[86:87] op_sel:[0,0] op_sel_hi:[1,0] neg_lo:[0,1] neg_hi:[0,1]
    v_pk_add_f32 v[164:165], v[164:165], s[86:87] op_sel:[0,0] op_sel_hi:[1,0] neg_lo:[0,1] neg_hi:[0,1]
    v_pk_add_f32 v[166:167], v[166:167], s[86:87] op_sel:[0,0] op_sel_hi:[1,0] neg_lo:[0,1] neg_hi:[0,1]
    v_pk_mul_f32 v[224:225], v[160:161], v[160:161]
    v_pk_fma_f32 v[224:225], v[162:163], v[162:163], v[224:225]
    v_pk_fma_f32 v[224:225], v[164:165], v[164:165], v[224:225]
    v_pk_fma_f32 v[224:225], v[166:167], v[166:167], v[224:225]
    v_add_f32 v218, v224, v225
    v_pk_add_f32 v[168:169], v[168:169], s[86:87] op_sel:[0,1] op_sel_hi:[1,1] neg_lo:[0,1] neg_hi:[0,1]
    v_pk_add_f32 v[170:171], v[170:171], s[86:87] op_sel:[0,1] op_sel_hi:[1,1] neg_lo:[0,1] neg_hi:[0,1]
    v_pk_add_f32 v[172:173], v[172:173], s[86:87] op_sel:[0,1] op_sel_hi:[1,1] neg_lo:[0,1] neg_hi:[0,1]
    v_pk_add_f32 v[174:175], v[174:175], s[86:87] op_sel:[0,1] op_sel_hi:[1,1] neg_lo:[0,1] neg_hi:[0,1]
    v_pk_mul_f32 v[224:225], v[168:169], v[168:169]
    v_pk_fma_f32 v[224:225], v[170:171], v[170:171], v[224:225]
    v_pk_fma_f32 v[224:225], v[172:173], v[172:173], v[224:225]
    v_pk_fma_f32 v[224:225], v[174:175], v[174:175], v[224:225]
    v_add_f32 v219, v224, v225
    v_pk_add_f32 v[176:177], v[176:177], s[88:89] op_sel:[0,0] op_sel_hi:[1,0] neg_lo:[0,1] neg_hi:[0,1]
    v_pk_add_f32 v[178:179], v[178:179], s[88:89] op_sel:[0,0] op_sel_hi:[1,0] neg_lo:[0,1] neg_hi:[0,1]
    v_pk_add_f32 v[180:181], v[180:181], s[88:89] op_sel:[0,0] op_sel_hi:[1,0] neg_lo:[0,1] neg_hi:[0,1]
    v_pk_add_f32 v[182:183], v[182:183], s[88:89] op_sel:[0,0] op_sel_hi:[1,0] neg_lo:[0,1] neg_hi:[0,1]
    v_pk_mul_f32 v[224:225], v[176:177], v[176:177]
    v_pk_fma_f32 v[224:225], v[178:179], v[178:179], v[224:225]
    v_pk_fma_f32 v[224:225], v[180:181], v[180:181], v[224:225]
    v_pk_fma_f32 v[224:225], v[182:183], v[182:183], v[224:225]
    v_add_f32 v220, v224, v225
    v_pk_add_f32 v[184:185], v[184:185], s[88:89] op_sel:[0,1] op_sel_hi:[1,1] neg_lo:[0,1] neg_hi:[0,1]
    v_pk_add_f32 v[186:187], v[186:187], s[88:89] op_sel:[0,1] op_sel_hi:[1,1] neg_lo:[0,1] neg_hi:[0,1]
    v_pk_add_f32 v[188:189], v[188:189], s[88:89] op_sel:[0,1] op_sel_hi:[1,1] neg_lo:[0,1] neg_hi:[0,1]
    v_pk_add_f32 v[190:191], v[190:191], s[88:89] op_sel:[0,1] op_sel_hi:[1,1] neg_lo:[0,1] neg_hi:[0,1]
    v_pk_mul_f32 v[224:225], v[184:185], v[184:185]
    v_pk_fma_f32 v[224:225], v[186:187], v[186:187], v[224:225]
    v_pk_fma_f32 v[224:225], v[188:189], v[188:189], v[224:225]
    v_pk_fma_f32 v[224:225], v[190:191], v[190:191], v[224:225]
    v_add_f32 v221, v224, v225
    v_pk_add_f32 v[192:193], v[192:193], s[90:91] op_sel:[0,0] op_sel_hi:[1,0] neg_lo:[0,1] neg_hi:[0,1]
    v_pk_add_f32 v[194:195], v[194:195], s[90:91] op_sel:[0,0] op_sel_hi:[1,0] neg_lo:[0,1] neg_hi:[0,1]
    v_pk_add_f32 v[196:197], v[196:197], s[90:91] op_sel:[0,0] op_sel_hi:[1,0] neg_lo:[0,1] neg_hi:[0,1]
    v_pk_add_f32 v[198:199], v[198:199], s[90:91] op_sel:[0,0] op_sel_hi:[1,0] neg_lo:[0,1] neg_hi:[0,1]
    v_pk_mul_f32 v[224:225], v[192:193], v[192:193]
    v_pk_fma_f32 v[224:225], v[194:195], v[194:195], v[224:225]
    v_pk_fma_f32 v[224:225], v[196:197], v[196:197], v[224:225]
    v_pk_fma_f32 v[224:225], v[198:199], v[198:199], v[224:225]
    v_add_f32 v222, v224, v225
    v_pk_add_f32 v[200:201], v[200:201], s[90:91] op_sel:[0,1] op_sel_hi:[1,1] neg_lo:[0,1] neg_hi:[0,1]
    v_pk_add_f32 v[202:203], v[202:203], s[90:91] op_sel:[0,1] op_sel_hi:[1,1] neg_lo:[0,1] neg_hi:[0,1]
    v_pk_add_f32 v[204:205], v[204:205], s[90:91] op_sel:[0,1] op_sel_hi:[1,1] neg_lo:[0,1] neg_hi:[0,1]
    v_pk_add_f32 v[206:207], v[206:207], s[90:91] op_sel:[0,1] op_sel_hi:[1,1] neg_lo:[0,1] neg_hi:[0,1]
    v_pk_mul_f32 v[224:225], v[200:201], v[200:201]
    v_pk_fma_f32 v[224:225], v[202:203], v[202:203], v[224:225]
    v_pk_fma_f32 v[224:225], v[204:205], v[204:205], v[224:225]
    v_pk_fma_f32 v[224:225], v[206:207], v[206:207], v[224:225]
    v_add_f32 v223, v224, v225
    v_permlane32_swap_b32 v208, v216
    v_permlane32_swap_b32 v209, v217
    v_permlane32_swap_b32 v210, v218
    v_permlane32_swap_b32 v211, v219
    v_permlane32_swap_b32 v212, v220
    v_permlane32_swap_b32 v213, v221
    v_permlane32_swap_b32 v214, v222
    v_permlane32_swap_b32 v215, v223
    v_add_f32 v208, v208, v216
    v_add_f32 v209, v209, v217
    v_add_f32 v210, v210, v218
    v_add_f32 v211, v211, v219
    v_add_f32 v212, v212, v220
    v_add_f32 v213, v213, v221
    v_add_f32 v214, v214, v222
    v_add_f32 v215, v215, v223
    v_permlane16_swap_b32 v208, v212
    v_permlane16_swap_b32 v209, v213
    v_permlane16_swap_b32 v210, v214
    v_permlane16_swap_b32 v211, v215
    v_add_f32 v208, v208, v212
    v_add_f32 v209, v209, v213
    v_add_f32 v210, v210, v214
    v_add_f32 v211, v211, v215
    s_nop 0
    v_add_f32_dpp v224, v208, v208 row_ror:8 row_mask:0xf bank_mask:0x3
    v_add_f32_dpp v225, v209, v209 row_ror:8 row_mask:0xf bank_mask:0x3
    s_nop 0
    v_add_f32_dpp v224, v210, v210 row_ror:8 row_mask:0xf bank_mask:0xc
    v_add_f32_dpp v225, v211, v211 row_ror:8 row_mask:0xf bank_mask:0xc
    s_nop 0
    v_add_f32_dpp v208, v224, v224 row_half_mirror row_mask:0xf bank_mask:0x5
    s_nop 1
    v_add_f32_dpp v208, v225, v225 row_half_mirror row_mask:0xf bank_mask:0xa
    s_nop 1
    v_add_f32_dpp v208, v208, v208 quad_perm:[1,0,3,2] row_mask:0xf bank_mask:0xf
    s_nop 1
    v_add_f32_dpp v208, v208, v208 quad_perm:[2,3,0,1] row_mask:0xf bank_mask:0xf
    v_mul_f32 v230, 0x3b000000, v208
    v_fma_f32 v230, -v229, v229, v230
    v_max_f32 v230, 0, v230
    v_cvt_pk_bf16_f32 v230, v230, v230
    v_and_b32 v230, 0xffff0000, v230
    v_add_f32 v230, 0x3727c5ac, v230
    v_cvt_pk_bf16_f32 v230, v230, v230
    v_and_b32 v230, 0xffff0000, v230
    v_sqrt_f32 v230, v230
    v_lshlrev_b32 v5, 1, v1
    v_cvt_pk_bf16_f32 v12, v228, v230
    s_lshl_b32 s46, s44, 3
    s_add_u32 s46, s46, 7340032
    s_mov_b32 exec_lo, 0x11111111
    s_mov_b32 exec_hi, 0x11111111
    s_waitcnt lgkmcnt(0)
    buffer_store_dwordx2 v[12:13], v5, s[8:11], s46 offen sc1
    s_mov_b64 exec, -1
    v_and_b32 v230, 0xffff0000, v12
    v_rcp_f32 v231, v230
    s_nop 0
    v_fma_f32 v229, -v230, v231, 1.0
    v_fma_f32 v231, v229, v231, v231
    s_nop 0
    v_readlane_b32 s76, v231, 0
    v_readlane_b32 s77, v231, 4
    v_readlane_b32 s78, v231, 8
    v_readlane_b32 s79, v231, 12
    v_readlane_b32 s80, v231, 16
    v_readlane_b32 s81, v231, 20
    v_readlane_b32 s82, v231, 24
    v_readlane_b32 s83, v231, 28
    v_readlane_b32 s84, v231, 32
    v_readlane_b32 s85, v231, 36
    v_readlane_b32 s86, v231, 40
    v_readlane_b32 s87, v231, 44
    v_readlane_b32 s88, v231, 48
    v_readlane_b32 s89, v231, 52
    v_readlane_b32 s90, v231, 56
    v_readlane_b32 s91, v231, 60
    v_pk_mul_f32 v[80:81], v[80:81], s[76:77] op_sel:[0,0] op_sel_hi:[1,0]
    v_pk_mul_f32 v[82:83], v[82:83], s[76:77] op_sel:[0,0] op_sel_hi:[1,0]
    v_pk_mul_f32 v[84:85], v[84:85], s[76:77] op_sel:[0,0] op_sel_hi:[1,0]
    v_pk_mul_f32 v[86:87], v[86:87], s[76:77] op_sel:[0,0] op_sel_hi:[1,0]
    v_pk_mul_f32 v[88:89], v[88:89], s[76:77] op_sel:[0,1] op_sel_hi:[1,1]
    v_pk_mul_f32 v[90:91], v[90:91], s[76:77] op_sel:[0,1] op_sel_hi:[1,1]
    v_pk_mul_f32 v[92:93], v[92:93], s[76:77] op_sel:[0,1] op_sel_hi:[1,1]
    v_pk_mul_f32 v[94:95], v[94:95], s[76:77] op_sel:[0,1] op_sel_hi:[1,1]
    v_pk_mul_f32 v[96:97], v[96:97], s[78:79] op_sel:[0,0] op_sel_hi:[1,0]
    v_pk_mul_f32 v[98:99], v[98:99], s[78:79] op_sel:[0,0] op_sel_hi:[1,0]
    v_pk_mul_f32 v[100:101], v[100:101], s[78:79] op_sel:[0,0] op_sel_hi:[1,0]
    v_pk_mul_f32 v[102:103], v[102:103], s[78:79] op_sel:[0,0] op_sel_hi:[1,0]
    v_pk_mul_f32 v[104:105], v[104:105], s[78:79] op_sel:[0,1] op_sel_hi:[1,1]
    v_pk_mul_f32 v[106:107], v[106:107], s[78:79] op_sel:[0,1] op_sel_hi:[1,1]
    v_pk_mul_f32 v[108:109], v[108:109], s[78:79] op_sel:[0,1] op_sel_hi:[1,1]
    v_pk_mul_f32 v[110:111], v[110:111], s[78:79] op_sel:[0,1] op_sel_hi:[1,1]
    v_pk_mul_f32 v[112:113], v[112:113], s[80:81] op_sel:[0,0] op_sel_hi:[1,0]
    v_pk_mul_f32 v[114:115], v[114:115], s[80:81] op_sel:[0,0] op_sel_hi:[1,0]
    v_pk_mul_f32 v[116:117], v[116:117], s[80:81] op_sel:[0,0] op_sel_hi:[1,0]
    v_pk_mul_f32 v[118:119], v[118:119], s[80:81] op_sel:[0,0] op_sel_hi:[1,0]
    v_pk_mul_f32 v[120:121], v[120:121], s[80:81] op_sel:[0,1] op_sel_hi:[1,1]
    v_pk_mul_f32 v[122:123], v[122:123], s[80:81] op_sel:[0,1] op_sel_hi:[1,1]
    v_pk_mul_f32 v[124:125], v[124:125], s[80:81] op_sel:[0,1] op_sel_hi:[1,1]
    v_pk_mul_f32 v[126:127], v[126:127], s[80:81] op_sel:[0,1] op_sel_hi:[1,1]
    v_pk_mul_f32 v[128:129], v[128:129], s[82:83] op_sel:[0,0] op_sel_hi:[1,0]
    v_pk_mul_f32 v[130:131], v[130:131], s[82:83] op_sel:[0,0] op_sel_hi:[1,0]
    v_pk_mul_f32 v[132:133], v[132:133], s[82:83] op_sel:[0,0] op_sel_hi:[1,0]
    v_pk_mul_f32 v[134:135], v[134:135], s[82:83] op_sel:[0,0] op_sel_hi:[1,0]
    v_pk_mul_f32 v[136:137], v[136:137], s[82:83] op_sel:[0,1] op_sel_hi:[1,1]
    v_pk_mul_f32 v[138:139], v[138:139], s[82:83] op_sel:[0,1] op_sel_hi:[1,1]
    v_pk_mul_f32 v[140:141], v[140:141], s[82:83] op_sel:[0,1] op_sel_hi:[1,1]
    v_pk_mul_f32 v[142:143], v[142:143], s[82:83] op_sel:[0,1] op_sel_hi:[1,1]
    v_cvt_pk_bf16_f32 v16, v80, v88
    v_cvt_pk_bf16_f32 v17, v96, v104
    v_cvt_pk_bf16_f32 v18, v112, v120
    v_cvt_pk_bf16_f32 v19, v128, v136
    ds_write_b128 v9, v[16:19] offset:0
    v_cvt_pk_bf16_f32 v20, v81, v89
    v_cvt_pk_bf16_f32 v21, v97, v105
    v_cvt_pk_bf16_f32 v22, v113, v121
    v_cvt_pk_bf16_f32 v23, v129, v137
    ds_write_b128 v9, v[20:23] offset:128
    v_cvt_pk_bf16_f32 v24, v82, v90
    v_cvt_pk_bf16_f32 v25, v98, v106
    v_cvt_pk_bf16_f32 v26, v114, v122
    v_cvt_pk_bf16_f32 v27, v130, v138
    ds_write_b128 v9, v[24:27] offset:256
    v_cvt_pk_bf16_f32 v28, v83, v91
    v_cvt_pk_bf16_f32 v29, v99, v107
    v_cvt_pk_bf16_f32 v30, v115, v123
    v_cvt_pk_bf16_f32 v31, v131, v139
    ds_write_b128 v9, v[28:31] offset:384
    v_cvt_pk_bf16_f32 v32, v84, v92
    v_cvt_pk_bf16_f32 v33, v100, v108
    v_cvt_pk_bf16_f32 v34, v116, v124
    v_cvt_pk_bf16_f32 v35, v132, v140
    ds_write_b128 v9, v[32:35] offset:512
    v_cvt_pk_bf16_f32 v36, v85, v93
    v_cvt_pk_bf16_f32 v37, v101, v109
    v_cvt_pk_bf16_f32 v38, v117, v125
    v_cvt_pk_bf16_f32 v39, v133, v141
    ds_write_b128 v9, v[36:39] offset:640
    v_cvt_pk_bf16_f32 v40, v86, v94
    v_cvt_pk_bf16_f32 v41, v102, v110
    v_cvt_pk_bf16_f32 v42, v118, v126
    v_cvt_pk_bf16_f32 v43, v134, v142
    ds_write_b128 v9, v[40:43] offset:768
    v_cvt_pk_bf16_f32 v44, v87, v95
    v_cvt_pk_bf16_f32 v45, v103, v111
    v_cvt_pk_bf16_f32 v46, v119, v127
    v_cvt_pk_bf16_f32 v47, v135, v143
    ds_write_b128 v9, v[44:47] offset:896
    v_pk_mul_f32 v[144:145], v[144:145], s[84:85] op_sel:[0,0] op_sel_hi:[1,0]
    v_pk_mul_f32 v[146:147], v[146:147], s[84:85] op_sel:[0,0] op_sel_hi:[1,0]
    v_pk_mul_f32 v[148:149], v[148:149], s[84:85] op_sel:[0,0] op_sel_hi:[1,0]
    v_pk_mul_f32 v[150:151], v[150:151], s[84:85] op_sel:[0,0] op_sel_hi:[1,0]
    v_pk_mul_f32 v[152:153], v[152:153], s[84:85] op_sel:[0,1] op_sel_hi:[1,1]
    v_pk_mul_f32 v[154:155], v[154:155], s[84:85] op_sel:[0,1] op_sel_hi:[1,1]
    v_pk_mul_f32 v[156:157], v[156:157], s[84:85] op_sel:[0,1] op_sel_hi:[1,1]
    v_pk_mul_f32 v[158:159], v[158:159], s[84:85] op_sel:[0,1] op_sel_hi:[1,1]
    v_pk_mul_f32 v[160:161], v[160:161], s[86:87] op_sel:[0,0] op_sel_hi:[1,0]
    v_pk_mul_f32 v[162:163], v[162:163], s[86:87] op_sel:[0,0] op_sel_hi:[1,0]
    v_pk_mul_f32 v[164:165], v[164:165], s[86:87] op_sel:[0,0] op_sel_hi:[1,0]
    v_pk_mul_f32 v[166:167], v[166:167], s[86:87] op_sel:[0,0] op_sel_hi:[1,0]
    v_pk_mul_f32 v[168:169], v[168:169], s[86:87] op_sel:[0,1] op_sel_hi:[1,1]
    v_pk_mul_f32 v[170:171], v[170:171], s[86:87] op_sel:[0,1] op_sel_hi:[1,1]
    v_pk_mul_f32 v[172:173], v[172:173], s[86:87] op_sel:[0,1] op_sel_hi:[1,1]
    v_pk_mul_f32 v[174:175], v[174:175], s[86:87] op_sel:[0,1] op_sel_hi:[1,1]
    v_pk_mul_f32 v[176:177], v[176:177], s[88:89] op_sel:[0,0] op_sel_hi:[1,0]
    v_pk_mul_f32 v[178:179], v[178:179], s[88:89] op_sel:[0,0] op_sel_hi:[1,0]
    v_pk_mul_f32 v[180:181], v[180:181], s[88:89] op_sel:[0,0] op_sel_hi:[1,0]
    v_pk_mul_f32 v[182:183], v[182:183], s[88:89] op_sel:[0,0] op_sel_hi:[1,0]
    v_pk_mul_f32 v[184:185], v[184:185], s[88:89] op_sel:[0,1] op_sel_hi:[1,1]
    v_pk_mul_f32 v[186:187], v[186:187], s[88:89] op_sel:[0,1] op_sel_hi:[1,1]
    v_pk_mul_f32 v[188:189], v[188:189], s[88:89] op_sel:[0,1] op_sel_hi:[1,1]
    v_pk_mul_f32 v[190:191], v[190:191], s[88:89] op_sel:[0,1] op_sel_hi:[1,1]
    v_pk_mul_f32 v[192:193], v[192:193], s[90:91] op_sel:[0,0] op_sel_hi:[1,0]
    v_pk_mul_f32 v[194:195], v[194:195], s[90:91] op_sel:[0,0] op_sel_hi:[1,0]
    v_pk_mul_f32 v[196:197], v[196:197], s[90:91] op_sel:[0,0] op_sel_hi:[1,0]
    v_pk_mul_f32 v[198:199], v[198:199], s[90:91] op_sel:[0,0] op_sel_hi:[1,0]
    v_pk_mul_f32 v[200:201], v[200:201], s[90:91] op_sel:[0,1] op_sel_hi:[1,1]
    v_pk_mul_f32 v[202:203], v[202:203], s[90:91] op_sel:[0,1] op_sel_hi:[1,1]
    v_pk_mul_f32 v[204:205], v[204:205], s[90:91] op_sel:[0,1] op_sel_hi:[1,1]
    v_pk_mul_f32 v[206:207], v[206:207], s[90:91] op_sel:[0,1] op_sel_hi:[1,1]
    v_cvt_pk_bf16_f32 v48, v144, v152
    v_cvt_pk_bf16_f32 v49, v160, v168
    v_cvt_pk_bf16_f32 v50, v176, v184
    v_cvt_pk_bf16_f32 v51, v192, v200
    ds_write_b128 v10, v[48:51] offset:0
    v_cvt_pk_bf16_f32 v52, v145, v153
    v_cvt_pk_bf16_f32 v53, v161, v169
    v_cvt_pk_bf16_f32 v54, v177, v185
    v_cvt_pk_bf16_f32 v55, v193, v201
    ds_write_b128 v10, v[52:55] offset:128
    v_cvt_pk_bf16_f32 v56, v146, v154
    v_cvt_pk_bf16_f32 v57, v162, v170
    v_cvt_pk_bf16_f32 v58, v178, v186
    v_cvt_pk_bf16_f32 v59, v194, v202
    ds_write_b128 v10, v[56:59] offset:256
    v_cvt_pk_bf16_f32 v60, v147, v155
    v_cvt_pk_bf16_f32 v61, v163, v171
    v_cvt_pk_bf16_f32 v62, v179, v187
    v_cvt_pk_bf16_f32 v63, v195, v203
    ds_write_b128 v10, v[60:63] offset:384
    v_cvt_pk_bf16_f32 v64, v148, v156
    v_cvt_pk_bf16_f32 v65, v164, v172
    v_cvt_pk_bf16_f32 v66, v180, v188
    v_cvt_pk_bf16_f32 v67, v196, v204
    ds_write_b128 v10, v[64:67] offset:512
    v_cvt_pk_bf16_f32 v68, v149, v157
    v_cvt_pk_bf16_f32 v69, v165, v173
    v_cvt_pk_bf16_f32 v70, v181, v189
    v_cvt_pk_bf16_f32 v71, v197, v205
    ds_write_b128 v10, v[68:71] offset:640
    v_cvt_pk_bf16_f32 v72, v150, v158
    v_cvt_pk_bf16_f32 v73, v166, v174
    v_cvt_pk_bf16_f32 v74, v182, v190
    v_cvt_pk_bf16_f32 v75, v198, v206
    ds_write_b128 v10, v[72:75] offset:768
    v_cvt_pk_bf16_f32 v76, v151, v159
    v_cvt_pk_bf16_f32 v77, v167, v175
    v_cvt_pk_bf16_f32 v78, v183, v191
    v_cvt_pk_bf16_f32 v79, v199, v207
    ds_write_b128 v10, v[76:79] offset:896
    s_mov_b64 exec, 1
    ds_add_u32 v6, v7 offset:24
    s_mov_b64 exec, -1
    s_mov_b64 s[76:77], 0
    v_lshlrev_b32 v4, 4, v1
    s_lshl_b32 s46, s4, 14
    v_add_u32 v2, s46, v4
    s_mul_i32 s47, s2, 65792
    s_add_u32 s46, s46, s47
    s_add_u32 s46, s46, 7864320
    v_xor_b32 v232, 0, v2
    v_xor_b32 v233, 16, v2
    v_xor_b32 v234, 32, v2
    v_xor_b32 v235, 48, v2
    v_xor_b32 v236, 64, v2
    v_xor_b32 v237, 80, v2
    v_xor_b32 v238, 96, v2
    v_xor_b32 v239, 112, v2
    s_mov_b32 s58, 2097152
F_lw_45:
    ds_read_b32 v3, v6 offset:24
    s_waitcnt lgkmcnt(0)
    v_readfirstlane_b32 s40, v3
    s_cmp_ge_u32 s40, 4
    s_cbranch_scc1 F_lwd_46
    s_sleep 1
    s_sub_u32 s58, s58, 1
    s_cmp_lg_u32 s58, 0
    s_cbranch_scc1 F_lw_45
F_lwd_46:
    ds_read_b128 v[128:131], v232 offset:0
    ds_read_b128 v[132:135], v233 offset:1024
    ds_read_b128 v[136:139], v234 offset:2048
    ds_read_b128 v[140:143], v235 offset:3072
    ds_read_b128 v[144:147], v236 offset:4096
    ds_read_b128 v[148:151], v237 offset:5120
    ds_read_b128 v[152:155], v238 offset:6144
    ds_read_b128 v[156:159], v239 offset:7168
    ds_read_b128 v[160:163], v232 offset:8192
    ds_read_b128 v[164:167], v233 offset:9216
    ds_read_b128 v[168:171], v234 offset:10240
    ds_read_b128 v[172:175], v235 offset:11264
    ds_read_b128 v[176:179], v236 offset:12288
    ds_read_b128 v[180:183], v237 offset:13312
    ds_read_b128 v[184:187], v238 offset:14336
    ds_read_b128 v[188:191], v239 offset:15360
    s_waitcnt lgkmcnt(0)
    s_mov_b64 exec, 1
    ds_add_u32 v6, v7 offset:4
    s_mov_b64 exec, -1
    buffer_store_dwordx4 v[128:131], v4, s[8:11], s46 offen offset:0 sc1
    buffer_store_dwordx4 v[132:135], v4, s[8:11], s46 offen offset:1024 sc1
    buffer_store_dwordx4 v[136:139], v4, s[8:11], s46 offen offset:2048 sc1
    buffer_store_dwordx4 v[140:143], v4, s[8:11], s46 offen offset:3072 sc1
    s_add_u32 s46, s46, 0x1000
    buffer_store_dwordx4 v[144:147], v4, s[8:11], s46 offen offset:0 sc1
    buffer_store_dwordx4 v[148:151], v4, s[8:11], s46 offen offset:1024 sc1
    buffer_store_dwordx4 v[152:155], v4, s[8:11], s46 offen offset:2048 sc1
    buffer_store_dwordx4 v[156:159], v4, s[8:11], s46 offen offset:3072 sc1
    s_add_u32 s46, s46, 0x1000
    buffer_store_dwordx4 v[160:163], v4, s[8:11], s46 offen offset:0 sc1
    buffer_store_dwordx4 v[164:167], v4, s[8:11], s46 offen offset:1024 sc1
    buffer_store_dwordx4 v[168:171], v4, s[8:11], s46 offen offset:2048 sc1
    buffer_store_dwordx4 v[172:175], v4, s[8:11], s46 offen offset:3072 sc1
    s_add_u32 s46, s46, 0x1000
    buffer_store_dwordx4 v[176:179], v4, s[8:11], s46 offen offset:0 sc1
    buffer_store_dwordx4 v[180:183], v4, s[8:11], s46 offen offset:1024 sc1
    buffer_store_dwordx4 v[184:187], v4, s[8:11], s46 offen offset:2048 sc1
    buffer_store_dwordx4 v[188:191], v4, s[8:11], s46 offen offset:3072 sc1
    s_lshl_b32 s46, s4, 7
    s_lshl_b32 s47, s2, 2
    s_add_u32 s46, s46, s47
    s_add_u32 s46, s46, 7393280
    s_waitcnt vmcnt(0)
    s_mov_b64 exec, 1
    buffer_store_dword v13, v15, s[8:11], s46 offen sc1
    s_mov_b64 exec, -1
    v_lshrrev_b32 v2, 4, v1
    v_bfe_u32 v3, v1, 1, 2
    v_xor_b32 v3, v3, v2
    v_and_b32 v4, 1, v1
    v_lshl_or_b32 v3, v3, 1, v4
    v_lshrrev_b32 v4, 3, v1
    v_lshlrev_b32 v4, 10, v4
    v_lshl_add_u32 v11, v3, 4, v4
    s_mul_i32 s86, s56, 458752
    s_lshl_b32 s40, s54, 7
    s_add_u32 s86, s86, s40
    s_add_u32 s87, s86, 458752
    s_mul_i32 s51, s54, 7
    s_lshr_b32 s51, s51, 2
    s_lshl_b32 s51, s51, 15
    s_add_u32 s51, s51, s86
    s_lshl_b32 s52, s56, 12
    s_mov_b32 s58, 2097152
F_lw_47:
    ds_read_b32 v2, v6 offset:4
    s_waitcnt lgkmcnt(0)
    v_readfirstlane_b32 s40, v2
    s_cmp_ge_u32 s40, 4
    s_cbranch_scc1 F_lwd_48
    s_sleep 1
    s_sub_u32 s58, s58, 1
    s_cmp_lg_u32 s58, 0
    s_cbranch_scc1 F_lw_47
F_lwd_48:
    s_add_u32 m0, s52, 65536
    s_add_u32 s49, s51, 0
    buffer_load_dwordx4 v11, s[24:27], s49 offen lds
    s_add_u32 m0, s52, 66560
    s_add_u32 s49, s51, 8192
    buffer_load_dwordx4 v11, s[24:27], s49 offen lds
    s_add_u32 m0, s52, 67584
    s_add_u32 s49, s51, 16384
    buffer_load_dwordx4 v11, s[24:27], s49 offen lds
    s_add_u32 m0, s52, 68608
    s_add_u32 s49, s51, 24576
    buffer_load_dwordx4 v11, s[24:27], s49 offen lds
    s_add_u32 s51, s51, 0x8000
    s_cmp_eq_u32 s51, s87
    s_cselect_b32 s51, s86, s51
    s_add_u32 m0, s52, 81920
    s_add_u32 s49, s51, 0
    buffer_load_dwordx4 v11, s[24:27], s49 offen lds
    s_add_u32 m0, s52, 82944
    s_add_u32 s49, s51, 8192
    buffer_load_dwordx4 v11, s[24:27], s49 offen lds
    s_add_u32 m0, s52, 83968
    s_add_u32 s49, s51, 16384
    buffer_load_dwordx4 v11, s[24:27], s49 offen lds
    s_add_u32 m0, s52, 84992
    s_add_u32 s49, s51, 24576
    buffer_load_dwordx4 v11, s[24:27], s49 offen lds
    s_add_u32 s51, s51, 0x8000
    s_cmp_eq_u32 s51, s87
    s_cselect_b32 s51, s86, s51
    s_add_u32 m0, s52, 0
    s_add_u32 s49, s51, 0
    buffer_load_dwordx4 v11, s[24:27], s49 offen lds
    s_add_u32 m0, s52, 1024
    s_add_u32 s49, s51, 8192
    buffer_load_dwordx4 v11, s[24:27], s49 offen lds
    s_add_u32 m0, s52, 2048
    s_add_u32 s49, s51, 16384
    buffer_load_dwordx4 v11, s[24:27], s49 offen lds
    s_add_u32 m0, s52, 3072
    s_add_u32 s49, s51, 24576
    buffer_load_dwordx4 v11, s[24:27], s49 offen lds
    s_add_u32 s51, s51, 0x8000
    s_cmp_eq_u32 s51, s87
    s_cselect_b32 s51, s86, s51
    s_add_u32 m0, s52, 16384
    s_add_u32 s49, s51, 0
    buffer_load_dwordx4 v11, s[24:27], s49 offen lds
    s_add_u32 m0, s52, 17408
    s_add_u32 s49, s51, 8192
    buffer_load_dwordx4 v11, s[24:27], s49 offen lds
    s_add_u32 m0, s52, 18432
    s_add_u32 s49, s51, 16384
    buffer_load_dwordx4 v11, s[24:27], s49 offen lds
    s_add_u32 m0, s52, 19456
    s_add_u32 s49, s51, 24576
    buffer_load_dwordx4 v11, s[24:27], s49 offen lds
    s_mov_b64 exec, -1
    s_mov_b32 s58, 2097152
F_poll_49:
    buffer_load_dword v3, v15, s[32:35], 0 offen sc1
    s_waitcnt vmcnt(0)
    v_cmp_eq_u32 vcc, 0, v3
    s_cbranch_vccz F_polld_50
    s_sleep 3
    s_sub_u32 s58, s58, 1
    s_cmp_lg_u32 s58, 0
    s_cbranch_scc1 F_poll_49
F_polld_50:
    s_mov_b64 exec, -1
    s_lshl_b32 s41, s56, 2
    v_add_u32 v2, s41, v6
    ds_write_b32 v6, v3 offset:8
    ds_write_b32 v2, v7 offset:32
    s_branch F_g2
F_aux2:
    s_lshr_b32 s46, s2, 1
    s_cmp_ge_u32 s46, 7
    s_cselect_b32 s47, 7, 0
    s_cselect_b32 s16, s20, s16
    s_cselect_b32 s17, s21, s17
    s_cselect_b32 s6, 1, 0
    s_sub_u32 s46, s46, s47
    s_and_b32 s48, s2, 1
    s_mul_i32 s48, s48, 7
    s_add_u32 s7, s46, s48
    s_lshl_b32 s45, s7, 8
    s_mul_i32 s46, s56, 14336
    s_add_u32 s45, s45, s46
    s_add_u32 s45, s45, 573440
    s_cmp_ge_u32 s2, 28
    s_cselect_b32 s18, 0, s18
    v_lshrrev_b32 v3, 4, v1
    v_mul_u32_u24 v3, 3584, v3
    v_and_b32 v4, 15, v1
    v_lshl_add_u32 v8, v4, 4, v3
    s_waitcnt lgkmcnt(0)
    s_or_b32 s61, s40, 1
    s_load_dwordx2 s[8:9], s[0:1], 104
    s_load_dwordx2 s[32:33], s[0:1], 96
    s_load_dwordx2 s[24:25], s[0:1], 80
    s_load_dwordx2 s[28:29], s[0:1], 88
    s_mov_b32 s10, 0x10000000
    s_mov_b32 s11, 0x20000
    s_mov_b32 s34, 0x100
    s_mov_b32 s35, 0x20000
    s_mov_b32 s26, 0x1c0000
    s_mov_b32 s27, 0x20000
    s_mov_b32 s30, 0x200000
    s_mov_b32 s31, 0x20000
    s_and_b32 s53, s2, 7
    s_lshl_b32 s53, s53, 2
    s_lshr_b32 s40, s2, 6
    s_add_u32 s53, s53, s40
    s_bfe_u32 s54, s2, 0x30003
    s_lshl_b32 s40, s2, 2
    s_waitcnt lgkmcnt(0)
    s_load_dword s63, s[74:75], s40
    s_cmp_lg_u32 s56, 0
    s_cbranch_scc1 F_atag_51
    v_mov_b32 v5, s61
    ds_write_b32 v6, v5 offset:256
    s_lshl_b32 s40, s2, 2
    s_mov_b64 exec, 1
    buffer_store_dword v5, v15, s[32:35], s40 offen sc1
    s_mov_b64 exec, -1
    v_lshl_add_u32 v2, v1, 2, v6
    v_mov_b32 v3, 0
    ds_write_b32 v2, v3
F_atag_51:
    s_waitcnt lgkmcnt(0)
    s_barrier
    ds_read_b32 v13, v6 offset:256
    buffer_load_dwordx4 v[128:131], v8, s[16:19], s45 offen
    s_add_u32 s45, s45, 57344
    buffer_load_dwordx4 v[132:135], v8, s[16:19], s45 offen
    s_add_u32 s45, s45, 57344
    buffer_load_dwordx4 v[136:139], v8, s[16:19], s45 offen
    s_add_u32 s45, s45, 57344
    buffer_load_dwordx4 v[140:143], v8, s[16:19], s45 offen
    s_add_u32 s45, s45, 57344
    buffer_load_dwordx4 v[144:147], v8, s[16:19], s45 offen
    s_add_u32 s45, s45, 57344
    buffer_load_dwordx4 v[148:151], v8, s[16:19], s45 offen
    s_add_u32 s45, s45, 57344
    buffer_load_dwordx4 v[152:155], v8, s[16:19], s45 offen
    s_add_u32 s45, s45, 57344
    buffer_load_dwordx4 v[156:159], v8, s[16:19], s45 offen
    s_add_u32 s45, s45, 57344
    buffer_load_dwordx4 v[160:163], v8, s[16:19], s45 offen
    s_add_u32 s45, s45, 57344
    buffer_load_dwordx4 v[164:167], v8, s[16:19], s45 offen
    s_add_u32 s45, s45, 57344
    buffer_load_dwordx4 v[168:171], v8, s[16:19], s45 offen
    s_add_u32 s45, s45, 57344
    buffer_load_dwordx4 v[172:175], v8, s[16:19], s45 offen
    s_add_u32 s45, s45, 57344
    buffer_load_dwordx4 v[176:179], v8, s[16:19], s45 offen
    s_add_u32 s45, s45, 57344
    buffer_load_dwordx4 v[180:183], v8, s[16:19], s45 offen
    s_add_u32 s45, s45, 57344
    buffer_load_dwordx4 v[184:187], v8, s[16:19], s45 offen
    s_add_u32 s45, s45, 57344
    buffer_load_dwordx4 v[188:191], v8, s[16:19], s45 offen
    s_add_u32 s45, s45, 57344
    buffer_load_dwordx4 v[192:195], v8, s[16:19], s45 offen
    s_add_u32 s45, s45, 57344
    buffer_load_dwordx4 v[196:199], v8, s[16:19], s45 offen
    s_add_u32 s45, s45, 57344
    buffer_load_dwordx4 v[200:203], v8, s[16:19], s45 offen
    s_add_u32 s45, s45, 57344
    buffer_load_dwordx4 v[204:207], v8, s[16:19], s45 offen
    s_add_u32 s45, s45, 57344
    buffer_load_dwordx4 v[208:211], v8, s[16:19], s45 offen
    s_add_u32 s45, s45, 57344
    buffer_load_dwordx4 v[212:215], v8, s[16:19], s45 offen
    s_sub_u32 s45, s45, 1777664
    buffer_load_dwordx4 v[216:219], v8, s[16:19], s45 offen
    s_add_u32 s45, s45, 57344
    buffer_load_dwordx4 v[220:223], v8, s[16:19], s45 offen
    s_add_u32 s45, s45, 57344
    buffer_load_dwordx4 v[224:227], v8, s[16:19], s45 offen
    s_add_u32 s45, s45, 57344
    buffer_load_dwordx4 v[228:231], v8, s[16:19], s45 offen
    s_add_u32 s45, s45, 57344
    buffer_load_dwordx4 v[232:235], v8, s[16:19], s45 offen
    s_add_u32 s45, s45, 57344
    buffer_load_dwordx4 v[236:239], v8, s[16:19], s45 offen
    s_add_u32 s45, s45, 57344
    buffer_load_dwordx4 v[240:243], v8, s[16:19], s45 offen
    s_add_u32 s45, s45, 57344
    buffer_load_dwordx4 v[244:247], v8, s[16:19], s45 offen
    s_add_u32 s45, s45, 57344
    buffer_load_dwordx4 v[248:251], v8, s[16:19], s45 offen
    s_add_u32 s45, s45, 57344
    buffer_load_dwordx4 v[252:255], v8, s[16:19], s45 offen
    v_and_b32 v3, 1, v1
    v_lshlrev_b32 v3, 4, v3
    v_mov_b32 v4, 0x3f80
    v_lshlrev_b32 v3, v3, v4
    v_bfe_u32 v4, v1, 1, 3
    v_cmp_eq_u32 s[78:79], 0, v4
    v_cmp_eq_u32 s[80:81], 1, v4
    v_cmp_eq_u32 s[82:83], 2, v4
    v_cmp_eq_u32 s[84:85], 3, v4
    v_cndmask_b32 v120, 0, v3, s[78:79]
    v_cndmask_b32 v121, 0, v3, s[80:81]
    v_cndmask_b32 v122, 0, v3, s[82:83]
    v_cndmask_b32 v123, 0, v3, s[84:85]
    v_and_b32 v4, 15, v1
    v_lshlrev_b32 v4, 5, v4
    v_bfe_u32 v5, v1, 4, 1
    v_lshl_add_u32 v4, v5, 4, v4
    s_lshl_b32 s46, s56, 9
    s_add_u32 s46, s46, 147968
    v_add_u32 v10, s46, v4
    s_waitcnt vmcnt(31)
    v_mfma_f32_16x16x32_bf16 v[124:127], v[120:123], v[128:131], 0
    s_waitcnt vmcnt(30)
    v_mfma_f32_16x16x32_bf16 v[124:127], v[120:123], v[132:135], v[124:127]
    s_waitcnt vmcnt(29)
    v_mfma_f32_16x16x32_bf16 v[124:127], v[120:123], v[136:139], v[124:127]
    s_waitcnt vmcnt(28)
    v_mfma_f32_16x16x32_bf16 v[124:127], v[120:123], v[140:143], v[124:127]
    s_waitcnt vmcnt(27)
    v_mfma_f32_16x16x32_bf16 v[124:127], v[120:123], v[144:147], v[124:127]
    s_waitcnt vmcnt(26)
    v_mfma_f32_16x16x32_bf16 v[124:127], v[120:123], v[148:151], v[124:127]
    s_waitcnt vmcnt(25)
    v_mfma_f32_16x16x32_bf16 v[124:127], v[120:123], v[152:155], v[124:127]
    s_waitcnt vmcnt(24)
    v_mfma_f32_16x16x32_bf16 v[124:127], v[120:123], v[156:159], v[124:127]
    s_waitcnt vmcnt(23)
    v_mfma_f32_16x16x32_bf16 v[124:127], v[120:123], v[160:163], v[124:127]
    s_waitcnt vmcnt(22)
    v_mfma_f32_16x16x32_bf16 v[124:127], v[120:123], v[164:167], v[124:127]
    s_waitcnt vmcnt(21)
    v_mfma_f32_16x16x32_bf16 v[124:127], v[120:123], v[168:171], v[124:127]
    s_waitcnt vmcnt(20)
    v_mfma_f32_16x16x32_bf16 v[124:127], v[120:123], v[172:175], v[124:127]
    s_waitcnt vmcnt(19)
    v_mfma_f32_16x16x32_bf16 v[124:127], v[120:123], v[176:179], v[124:127]
    s_waitcnt vmcnt(18)
    v_mfma_f32_16x16x32_bf16 v[124:127], v[120:123], v[180:183], v[124:127]
    s_waitcnt vmcnt(17)
    v_mfma_f32_16x16x32_bf16 v[124:127], v[120:123], v[184:187], v[124:127]
    s_waitcnt vmcnt(16)
    v_mfma_f32_16x16x32_bf16 v[124:127], v[120:123], v[188:191], v[124:127]
    s_waitcnt vmcnt(15)
    v_mfma_f32_16x16x32_bf16 v[124:127], v[120:123], v[192:195], v[124:127]
    s_waitcnt vmcnt(14)
    v_mfma_f32_16x16x32_bf16 v[124:127], v[120:123], v[196:199], v[124:127]
    s_waitcnt vmcnt(13)
    v_mfma_f32_16x16x32_bf16 v[124:127], v[120:123], v[200:203], v[124:127]
    s_waitcnt vmcnt(12)
    v_mfma_f32_16x16x32_bf16 v[124:127], v[120:123], v[204:207], v[124:127]
    s_waitcnt vmcnt(11)
    v_mfma_f32_16x16x32_bf16 v[124:127], v[120:123], v[208:211], v[124:127]
    s_waitcnt vmcnt(10)
    v_mfma_f32_16x16x32_bf16 v[124:127], v[120:123], v[212:215], v[124:127]
    s_waitcnt vmcnt(9)
    v_mfma_f32_16x16x32_bf16 v[124:127], v[120:123], v[216:219], v[124:127]
    s_waitcnt vmcnt(8)
    v_mfma_f32_16x16x32_bf16 v[124:127], v[120:123], v[220:223], v[124:127]
    s_waitcnt vmcnt(7)
    v_mfma_f32_16x16x32_bf16 v[124:127], v[120:123], v[224:227], v[124:127]
    s_waitcnt vmcnt(6)
    v_mfma_f32_16x16x32_bf16 v[124:127], v[120:123], v[228:231], v[124:127]
    s_waitcnt vmcnt(5)
    v_mfma_f32_16x16x32_bf16 v[124:127], v[120:123], v[232:235], v[124:127]
    s_waitcnt vmcnt(4)
    v_mfma_f32_16x16x32_bf16 v[124:127], v[120:123], v[236:239], v[124:127]
    s_waitcnt vmcnt(3)
    v_mfma_f32_16x16x32_bf16 v[124:127], v[120:123], v[240:243], v[124:127]
    s_waitcnt vmcnt(2)
    v_mfma_f32_16x16x32_bf16 v[124:127], v[120:123], v[244:247], v[124:127]
    s_waitcnt vmcnt(1)
    v_mfma_f32_16x16x32_bf16 v[124:127], v[120:123], v[248:251], v[124:127]
    s_waitcnt vmcnt(0)
    v_mfma_f32_16x16x32_bf16 v[124:127], v[120:123], v[252:255], v[124:127]
    s_mov_b32 exec_hi, 0
    s_nop 6
    ds_write_b128 v10, v[124:127]
    s_mov_b64 exec, -1
    s_mov_b64 exec, 1
    ds_add_u32 v6, v7 offset:12
    s_mov_b64 exec, -1
    s_cmp_ge_u32 s2, 28
    s_cbranch_scc1 F_nocs_52
    s_cmp_ge_u32 s56, 2
    s_cbranch_scc1 F_nocs_52
    s_mov_b32 s58, 2097152
F_lw_53:
    ds_read_b32 v2, v6 offset:12
    s_waitcnt lgkmcnt(0)
    v_readfirstlane_b32 s40, v2
    s_cmp_ge_u32 s40, 4
    s_cbranch_scc1 F_lwd_54
    s_sleep 1
    s_sub_u32 s58, s58, 1
    s_cmp_lg_u32 s58, 0
    s_cbranch_scc1 F_lw_53
F_lwd_54:
    v_and_b32 v3, 127, v0
    v_lshlrev_b32 v5, 2, v3
    v_add_u32 v5, 147968, v5
    ds_read2st64_b32 v[192:193], v5 offset0:0 offset1:2
    ds_read2st64_b32 v[194:195], v5 offset0:4 offset1:6
    v_lshlrev_b32 v3, 3, v3
    s_mul_i32 s47, s6, 14
    s_add_u32 s47, s47, s7
    s_lshl_b32 s47, s47, 10
    s_add_u32 s47, s47, 7356416
    s_waitcnt lgkmcnt(0)
    v_pk_add_f32 v[192:193], v[192:193], v[194:195]
    v_add_f32 v12, v192, v193
    buffer_store_dwordx2 v[12:13], v3, s[8:11], s47 offen sc1
F_nocs_52:
    v_mov_b32 v6, 163328
    v_mov_b32 v7, 1
    s_lshl_b32 s40, s56, 12
    s_add_u32 s40, s40, 114688
    v_lshl_add_u32 v20, v1, 2, s40
    v_xor_b32 v21, 16, v20
    v_xor_b32 v22, 32, v20
    v_xor_b32 v23, 48, v20
    v_xor_b32 v24, 64, v20
    v_xor_b32 v25, 80, v20
    v_xor_b32 v26, 96, v20
    v_xor_b32 v27, 112, v20
    v_and_b32 v58, 15, v1
    v_lshrrev_b32 v59, 4, v1
    v_lshrrev_b32 v60, 1, v58
    v_xor_b32 v60, v60, v59
    v_lshlrev_b32 v60, 4, v60
    v_lshl_add_u32 v60, v58, 8, v60
    v_add_u32 v28, s40, v60
    v_xor_b32 v29, 64, v28
    v_xor_b32 v30, 128, v28
    v_xor_b32 v31, 192, v28
    s_lshr_b32 s5, s56, 1
    s_mul_i32 s41, s5, 3072
    s_add_u32 s41, s41, 155648
    v_lshrrev_b32 v60, 1, v59
    v_lshlrev_b32 v60, 8, v60
    v_and_b32 v61, 1, v59
    v_lshl_add_u32 v60, v61, 3, v60
    v_lshl_add_u32 v60, v58, 4, v60
    v_add_u32 v32, s41, v60
    v_cmp_gt_u32 vcc, 2, v59
    v_lshlrev_b32 v60, 7, v59
    v_lshlrev_b32 v61, 2, v58
    v_lshlrev_b32 v62, 3, v58
    v_cndmask_b32 v61, v61, v62, vcc
    v_add3_u32 v33, v60, v61, s41
    v_mov_b32 v61, 64
    v_cndmask_b32 v61, v61, 4, vcc
    v_add_u32 v34, v33, v61
    v_lshl_add_u32 v60, v58, 1, v60
    v_add_u32 v35, s41, v60
    v_lshrrev_b32 v2, 4, v1
    v_bfe_u32 v3, v1, 1, 2
    v_xor_b32 v3, v3, v2
    v_and_b32 v4, 1, v1
    v_lshl_or_b32 v3, v3, 1, v4
    v_lshrrev_b32 v4, 3, v1
    v_lshlrev_b32 v4, 10, v4
    v_lshl_add_u32 v11, v3, 4, v4
    s_mul_i32 s86, s56, 458752
    s_lshl_b32 s40, s54, 7
    s_add_u32 s86, s86, s40
    s_add_u32 s87, s86, 458752
    s_mul_i32 s51, s54, 7
    s_lshr_b32 s51, s51, 2
    s_lshl_b32 s51, s51, 15
    s_add_u32 s51, s51, s86
    s_lshl_b32 s52, s56, 12
    v_mov_b32 v6, 163328
    v_mov_b32 v7, 1
    v_and_b32 v14, 31, v1
    v_lshlrev_b32 v14, 2, v14
    s_lshr_b32 s5, s56, 1
    v_and_b32 v58, 15, v1
    v_lshrrev_b32 v59, 4, v1
    v_and_b32 v60, 3, v1
    v_mul_u32_u24 v49, 4160, v60
    v_lshl_add_u32 v49, v59, 4, v49
    v_and_b32 v60, 12, v1
    v_lshlrev_b32 v60, 1, v60
    v_sub_u32 v49, v49, v60
    s_mul_i32 s40, s5, 16640
    s_and_b32 s39, s56, 1
    s_lshl_b32 s39, s39, 8
    s_sub_u32 s40, s40, s39
    s_add_u32 s40, s40, 114976
    v_add_u32 v49, s40, v49
    v_lshlrev_b32 v51, 5, v58
    v_lshl_add_u32 v50, v59, 4, v51
    v_lshl_add_u32 v52, v59, 3, v51
    s_mul_i32 s40, s5, 4608
    s_add_u32 s41, s40, 148448
    v_add_u32 v51, s41, v52
    v_mul_u32_u24 v52, 67584, v59
    v_lshl_add_u32 v52, v58, 3, v52
    s_sub_u32 s40, s40, s39
    s_add_u32 s40, s40, 148224
    v_add_u32 v50, s40, v50
    v_and_b32 v54, 255, v0
    v_lshlrev_b32 v58, 3, v54
    v_lshlrev_b32 v54, 4, v54
    v_bfe_u32 v59, v0, 4, 4
    v_and_b32 v55, 0xf0, v54
    v_mul_u32_u24 v53, 65792, v59
    v_add_u32 v55, v55, v53
    v_and_b32 v53, 0x70, v54
    v_lshl_add_u32 v53, v59, 7, v53
    v_bfe_u32 v59, v0, 3, 1
    v_mul_u32_u24 v59, 4608, v59
    v_add_u32 v53, v53, v59
    v_add_u32 v53, 148448, v53
    v_sub_u32 v58, 2051, v58
    s_movk_i32 s41, 128
    s_mov_b32 s40, 155648
    v_subrev_u32 v59, 0, v58
    v_cvt_f32_u32 v60, v59
    v_cvt_pk_bf16_f32 v60, v60, v60
    v_lshrrev_b32 v60, 16, v60
    v_subrev_u32 v60, 0x4280, v60
    v_med3_i32 v60, v60, v59, s41
    v_lshl_add_u32 v38, v60, 1, s40
    v_subrev_u32 v59, 1, v58
    v_cvt_f32_u32 v60, v59
    v_cvt_pk_bf16_f32 v60, v60, v60
    v_lshrrev_b32 v60, 16, v60
    v_subrev_u32 v60, 0x4280, v60
    v_med3_i32 v60, v60, v59, s41
    v_lshl_add_u32 v39, v60, 1, s40
    v_subrev_u32 v59, 2, v58
    v_cvt_f32_u32 v60, v59
    v_cvt_pk_bf16_f32 v60, v60, v60
    v_lshrrev_b32 v60, 16, v60
    v_subrev_u32 v60, 0x4280, v60
    v_med3_i32 v60, v60, v59, s41
    v_lshl_add_u32 v40, v60, 1, s40
    v_subrev_u32 v59, 3, v58
    v_cvt_f32_u32 v60, v59
    v_cvt_pk_bf16_f32 v60, v60, v60
    v_lshrrev_b32 v60, 16, v60
    v_subrev_u32 v60, 0x4280, v60
    v_med3_i32 v60, v60, v59, s41
    v_lshl_add_u32 v41, v60, 1, s40
    v_subrev_u32 v59, 4, v58
    v_cvt_f32_u32 v60, v59
    v_cvt_pk_bf16_f32 v60, v60, v60
    v_lshrrev_b32 v60, 16, v60
    v_subrev_u32 v60, 0x4280, v60
    v_med3_i32 v60, v60, v59, s41
    v_lshl_add_u32 v42, v60, 1, s40
    v_subrev_u32 v59, 5, v58
    v_cvt_f32_u32 v60, v59
    v_cvt_pk_bf16_f32 v60, v60, v60
    v_lshrrev_b32 v60, 16, v60
    v_subrev_u32 v60, 0x4280, v60
    v_med3_i32 v60, v60, v59, s41
    v_lshl_add_u32 v43, v60, 1, s40
    v_subrev_u32 v59, 6, v58
    v_cvt_f32_u32 v60, v59
    v_cvt_pk_bf16_f32 v60, v60, v60
    v_lshrrev_b32 v60, 16, v60
    v_subrev_u32 v60, 0x4280, v60
    v_med3_i32 v60, v60, v59, s41
    v_lshl_add_u32 v44, v60, 1, s40
    v_subrev_u32 v59, 7, v58
    v_cvt_f32_u32 v60, v59
    v_cvt_pk_bf16_f32 v60, v60, v60
    v_lshrrev_b32 v60, 16, v60
    v_subrev_u32 v60, 0x4280, v60
    v_med3_i32 v60, v60, v59, s41
    v_lshl_add_u32 v45, v60, 1, s40
    v_subrev_u32 v59, 8, v58
    v_cvt_f32_u32 v60, v59
    v_cvt_pk_bf16_f32 v60, v60, v60
    v_lshrrev_b32 v60, 16, v60
    v_subrev_u32 v60, 0x4280, v60
    v_med3_i32 v60, v60, v59, s41
    v_lshl_add_u32 v46, v60, 1, s40
    v_subrev_u32 v59, 9, v58
    v_cvt_f32_u32 v60, v59
    v_cvt_pk_bf16_f32 v60, v60, v60
    v_lshrrev_b32 v60, 16, v60
    v_subrev_u32 v60, 0x4280, v60
    v_med3_i32 v60, v60, v59, s41
    v_lshl_add_u32 v47, v60, 1, s40
    v_subrev_u32 v59, 10, v58
    v_cvt_f32_u32 v60, v59
    v_cvt_pk_bf16_f32 v60, v60, v60
    v_lshrrev_b32 v60, 16, v60
    v_subrev_u32 v60, 0x4280, v60
    v_med3_i32 v60, v60, v59, s41
    v_lshl_add_u32 v48, v60, 1, s40
    buffer_load_dword v36, v14, s[32:35], 0 offen sc1
    s_waitcnt lgkmcnt(0)
    s_lshl_b32 s3, s5, 4
    s_lshr_b32 s3, s59, s3
    s_lshl_b32 s3, s3, 16
    v_mov_b32 v61, 0x3fb8aa3b
    v_mul_f32 v61, s3, v61
    v_lshlrev_b32 v16, 16, v16
    v_lshlrev_b32 v17, 16, v17
    v_lshlrev_b32 v18, 16, v18
    v_lshlrev_b32 v19, 16, v19
    v_mul_f32 v16, 0x3fb8aa3b, v16
    v_exp_f32 v16, v16
    v_exp_f32 v61, v61
    s_nop 0
    v_cvt_pk_bf16_f32 v58, v61, v16
    v_lshlrev_b32 v61, 16, v58
    v_and_b32 v16, 0xffff0000, v58
    v_mul_f32 v56, v16, v61
    v_mul_f32 v57, v17, v61
    v_mul_f32 v56, 0xbfb8aa3b, v56
    v_mul_f32 v57, 0x3e22f983, v57
    v_mul_f32 v62, v18, v61
    v_mul_f32 v63, v19, v61
    v_add_f32 v62, v62, v62
    v_add_f32 v63, v63, v63
    v_mul_f32 v110, 0x41000000, v56
    v_mul_f32 v111, 0x41000000, v57
    v_mul_f32 v112, 0x41800000, v56
    v_mul_f32 v113, 0x41800000, v57
    v_mul_f32 v114, 0x3f800000, v56
    v_mul_f32 v115, 0x3f800000, v57
    v_mul_f32 v116, 0x43000000, v56
    v_mul_f32 v117, 0x43000000, v57
    v_mul_f32 v118, 0x44800000, v56
    v_mul_f32 v119, 0x44800000, v57
    v_fract_f32 v111, v111
    v_exp_f32 v110, v110
    v_fract_f32 v113, v113
    v_exp_f32 v112, v112
    v_fract_f32 v115, v115
    v_exp_f32 v114, v114
    v_fract_f32 v117, v117
    v_exp_f32 v116, v116
    v_fract_f32 v119, v119
    v_exp_f32 v118, v118
    v_cos_f32 v64, v111
    v_sin_f32 v65, v111
    v_cos_f32 v106, v113
    v_sin_f32 v107, v113
    v_cos_f32 v78, v115
    v_sin_f32 v79, v115
    v_cos_f32 v92, v117
    v_sin_f32 v93, v117
    v_cos_f32 v66, v119
    v_sin_f32 v67, v119
    v_mul_f32 v64, v64, v110
    v_mul_f32 v65, v65, v110
    v_mul_f32 v106, v106, v112
    v_mul_f32 v107, v107, v112
    v_mul_f32 v78, v78, v114
    v_mul_f32 v79, v79, v114
    v_mul_f32 v92, v92, v116
    v_mul_f32 v93, v93, v116
    v_mul_f32 v66, v66, v118
    v_mul_f32 v67, v67, v118
    v_pk_mul_f32 v[110:111], v[62:63], v[64:65] op_sel_hi:[1,0]
    v_pk_fma_f32 v[108:109], v[62:63], v[64:65], v[110:111] op_sel:[1,1,0] op_sel_hi:[0,1,1] neg_lo:[1,0,0]
    v_cvt_pk_bf16_f32 v128, v62, -v63
    v_cvt_pk_bf16_f32 v129, v108, -v109
    v_pk_mul_f32 v[110:111], v[62:63], v[106:107] op_sel_hi:[1,0]
    v_pk_mul_f32 v[112:113], v[108:109], v[106:107] op_sel_hi:[1,0]
    v_pk_mul_f32 v[114:115], v[78:79], v[78:79] op_sel_hi:[1,0]
    v_pk_mul_f32 v[116:117], v[92:93], v[92:93] op_sel_hi:[1,0]
    v_pk_fma_f32 v[62:63], v[62:63], v[106:107], v[110:111] op_sel:[1,1,0] op_sel_hi:[0,1,1] neg_lo:[1,0,0]
    v_pk_fma_f32 v[108:109], v[108:109], v[106:107], v[112:113] op_sel:[1,1,0] op_sel_hi:[0,1,1] neg_lo:[1,0,0]
    v_pk_fma_f32 v[80:81], v[78:79], v[78:79], v[114:115] op_sel:[1,1,0] op_sel_hi:[0,1,1] neg_lo:[1,0,0]
    v_pk_fma_f32 v[94:95], v[92:93], v[92:93], v[116:117] op_sel:[1,1,0] op_sel_hi:[0,1,1] neg_lo:[1,0,0]
    ds_write2st64_b32 v20, v128, v129 offset0:0 offset1:1
    v_cvt_pk_bf16_f32 v130, v62, -v63
    v_cvt_pk_bf16_f32 v131, v108, -v109
    v_pk_mul_f32 v[110:111], v[62:63], v[106:107] op_sel_hi:[1,0]
    v_pk_mul_f32 v[112:113], v[108:109], v[106:107] op_sel_hi:[1,0]
    v_pk_mul_f32 v[114:115], v[80:81], v[78:79] op_sel_hi:[1,0]
    v_pk_mul_f32 v[116:117], v[94:95], v[92:93] op_sel_hi:[1,0]
    v_pk_fma_f32 v[62:63], v[62:63], v[106:107], v[110:111] op_sel:[1,1,0] op_sel_hi:[0,1,1] neg_lo:[1,0,0]
    v_pk_fma_f32 v[108:109], v[108:109], v[106:107], v[112:113] op_sel:[1,1,0] op_sel_hi:[0,1,1] neg_lo:[1,0,0]
    v_pk_fma_f32 v[82:83], v[80:81], v[78:79], v[114:115] op_sel:[1,1,0] op_sel_hi:[0,1,1] neg_lo:[1,0,0]
    v_pk_fma_f32 v[96:97], v[94:95], v[92:93], v[116:117] op_sel:[1,1,0] op_sel_hi:[0,1,1] neg_lo:[1,0,0]
    ds_write2st64_b32 v21, v130, v131 offset0:2 offset1:3
    v_cvt_pk_bf16_f32 v132, v62, -v63
    v_cvt_pk_bf16_f32 v133, v108, -v109
    v_pk_mul_f32 v[110:111], v[62:63], v[106:107] op_sel_hi:[1,0]
    v_pk_mul_f32 v[112:113], v[108:109], v[106:107] op_sel_hi:[1,0]
    v_pk_mul_f32 v[114:115], v[82:83], v[78:79] op_sel_hi:[1,0]
    v_pk_mul_f32 v[116:117], v[96:97], v[92:93] op_sel_hi:[1,0]
    v_pk_fma_f32 v[62:63], v[62:63], v[106:107], v[110:111] op_sel:[1,1,0] op_sel_hi:[0,1,1] neg_lo:[1,0,0]
    v_pk_fma_f32 v[108:109], v[108:109], v[106:107], v[112:113] op_sel:[1,1,0] op_sel_hi:[0,1,1] neg_lo:[1,0,0]
    v_pk_fma_f32 v[84:85], v[82:83], v[78:79], v[114:115] op_sel:[1,1,0] op_sel_hi:[0,1,1] neg_lo:[1,0,0]
    v_pk_fma_f32 v[98:99], v[96:97], v[92:93], v[116:117] op_sel:[1,1,0] op_sel_hi:[0,1,1] neg_lo:[1,0,0]
    ds_write2st64_b32 v22, v132, v133 offset0:4 offset1:5
    v_cvt_pk_bf16_f32 v134, v62, -v63
    v_cvt_pk_bf16_f32 v135, v108, -v109
    v_pk_mul_f32 v[110:111], v[62:63], v[106:107] op_sel_hi:[1,0]
    v_pk_mul_f32 v[112:113], v[108:109], v[106:107] op_sel_hi:[1,0]
    v_pk_mul_f32 v[114:115], v[84:85], v[78:79] op_sel_hi:[1,0]
    v_pk_mul_f32 v[116:117], v[98:99], v[92:93] op_sel_hi:[1,0]
    v_pk_fma_f32 v[62:63], v[62:63], v[106:107], v[110:111] op_sel:[1,1,0] op_sel_hi:[0,1,1] neg_lo:[1,0,0]
    v_pk_fma_f32 v[108:109], v[108:109], v[106:107], v[112:113] op_sel:[1,1,0] op_sel_hi:[0,1,1] neg_lo:[1,0,0]
    v_pk_fma_f32 v[86:87], v[84:85], v[78:79], v[114:115] op_sel:[1,1,0] op_sel_hi:[0,1,1] neg_lo:[1,0,0]
    v_pk_fma_f32 v[100:101], v[98:99], v[92:93], v[116:117] op_sel:[1,1,0] op_sel_hi:[0,1,1] neg_lo:[1,0,0]
    ds_write2st64_b32 v23, v134, v135 offset0:6 offset1:7
    v_cvt_pk_bf16_f32 v136, v62, -v63
    v_cvt_pk_bf16_f32 v137, v108, -v109
    v_pk_mul_f32 v[110:111], v[62:63], v[106:107] op_sel_hi:[1,0]
    v_pk_mul_f32 v[112:113], v[108:109], v[106:107] op_sel_hi:[1,0]
    v_pk_mul_f32 v[114:115], v[86:87], v[78:79] op_sel_hi:[1,0]
    v_pk_mul_f32 v[116:117], v[100:101], v[92:93] op_sel_hi:[1,0]
    v_pk_fma_f32 v[62:63], v[62:63], v[106:107], v[110:111] op_sel:[1,1,0] op_sel_hi:[0,1,1] neg_lo:[1,0,0]
    v_pk_fma_f32 v[108:109], v[108:109], v[106:107], v[112:113] op_sel:[1,1,0] op_sel_hi:[0,1,1] neg_lo:[1,0,0]
    v_pk_fma_f32 v[88:89], v[86:87], v[78:79], v[114:115] op_sel:[1,1,0] op_sel_hi:[0,1,1] neg_lo:[1,0,0]
    v_pk_fma_f32 v[102:103], v[100:101], v[92:93], v[116:117] op_sel:[1,1,0] op_sel_hi:[0,1,1] neg_lo:[1,0,0]
    ds_write2st64_b32 v24, v136, v137 offset0:8 offset1:9
    v_cvt_pk_bf16_f32 v138, v62, -v63
    v_cvt_pk_bf16_f32 v139, v108, -v109
    v_pk_mul_f32 v[110:111], v[62:63], v[106:107] op_sel_hi:[1,0]
    v_pk_mul_f32 v[112:113], v[108:109], v[106:107] op_sel_hi:[1,0]
    v_pk_mul_f32 v[114:115], v[88:89], v[78:79] op_sel_hi:[1,0]
    v_pk_mul_f32 v[116:117], v[102:103], v[92:93] op_sel_hi:[1,0]
    v_pk_fma_f32 v[62:63], v[62:63], v[106:107], v[110:111] op_sel:[1,1,0] op_sel_hi:[0,1,1] neg_lo:[1,0,0]
    v_pk_fma_f32 v[108:109], v[108:109], v[106:107], v[112:113] op_sel:[1,1,0] op_sel_hi:[0,1,1] neg_lo:[1,0,0]
    v_pk_fma_f32 v[90:91], v[88:89], v[78:79], v[114:115] op_sel:[1,1,0] op_sel_hi:[0,1,1] neg_lo:[1,0,0]
    v_pk_fma_f32 v[104:105], v[102:103], v[92:93], v[116:117] op_sel:[1,1,0] op_sel_hi:[0,1,1] neg_lo:[1,0,0]
    ds_write2st64_b32 v25, v138, v139 offset0:10 offset1:11
    v_cvt_pk_bf16_f32 v140, v62, -v63
    v_cvt_pk_bf16_f32 v141, v108, -v109
    v_pk_mul_f32 v[110:111], v[62:63], v[106:107] op_sel_hi:[1,0]
    v_pk_mul_f32 v[112:113], v[108:109], v[106:107] op_sel_hi:[1,0]
    v_pk_fma_f32 v[62:63], v[62:63], v[106:107], v[110:111] op_sel:[1,1,0] op_sel_hi:[0,1,1] neg_lo:[1,0,0]
    v_pk_fma_f32 v[108:109], v[108:109], v[106:107], v[112:113] op_sel:[1,1,0] op_sel_hi:[0,1,1] neg_lo:[1,0,0]
    ds_write2st64_b32 v26, v140, v141 offset0:12 offset1:13
    v_cvt_pk_bf16_f32 v142, v62, -v63
    v_cvt_pk_bf16_f32 v143, v108, -v109
    ds_write2st64_b32 v27, v142, v143 offset0:14 offset1:15
    v_mov_b32 v144, 0x3f80
    ds_read_b128 v[192:195], v28
    ds_read_b128 v[196:199], v29
    ds_read_b128 v[200:203], v30
    ds_read_b128 v[204:207], v31
    v_cvt_pk_bf16_f32 v145, v78, v79
    ds_write2st64_b32 v20, v144, v145 offset0:0 offset1:1
    v_cvt_pk_bf16_f32 v146, v80, v81
    v_cvt_pk_bf16_f32 v147, v82, v83
    ds_write2st64_b32 v21, v146, v147 offset0:2 offset1:3
    v_cvt_pk_bf16_f32 v148, v84, v85
    v_cvt_pk_bf16_f32 v149, v86, v87
    ds_write2st64_b32 v22, v148, v149 offset0:4 offset1:5
    v_cvt_pk_bf16_f32 v150, v88, v89
    v_cvt_pk_bf16_f32 v151, v90, v91
    ds_write2st64_b32 v23, v150, v151 offset0:6 offset1:7
    v_cvt_pk_bf16_f32 v152, v92, v93
    v_cvt_pk_bf16_f32 v160, v94, v95
    v_cvt_pk_bf16_f32 v164, v96, v97
    v_cvt_pk_bf16_f32 v176, v66, v67
    v_cvt_pk_bf16_f32 v168, v98, v99
    v_cvt_pk_bf16_f32 v170, v100, v101
    v_cvt_pk_bf16_f32 v172, v102, v103
    v_cvt_pk_bf16_f32 v174, v104, v105
    v_pk_mul_f32 v[110:111], v[92:93], v[78:79] op_sel_hi:[1,0]
    v_pk_mul_f32 v[112:113], v[92:93], v[80:81] op_sel_hi:[1,0]
    v_pk_mul_f32 v[114:115], v[92:93], v[82:83] op_sel_hi:[1,0]
    v_pk_mul_f32 v[116:117], v[92:93], v[84:85] op_sel_hi:[1,0]
    v_pk_fma_f32 v[120:121], v[92:93], v[78:79], v[110:111] op_sel:[1,1,0] op_sel_hi:[0,1,1] neg_lo:[1,0,0]
    v_pk_fma_f32 v[122:123], v[92:93], v[80:81], v[112:113] op_sel:[1,1,0] op_sel_hi:[0,1,1] neg_lo:[1,0,0]
    v_pk_fma_f32 v[124:125], v[92:93], v[82:83], v[114:115] op_sel:[1,1,0] op_sel_hi:[0,1,1] neg_lo:[1,0,0]
    v_pk_fma_f32 v[126:127], v[92:93], v[84:85], v[116:117] op_sel:[1,1,0] op_sel_hi:[0,1,1] neg_lo:[1,0,0]
    v_cvt_pk_bf16_f32 v153, v120, v121
    ds_write2st64_b32 v24, v152, v153 offset0:8 offset1:9
    v_cvt_pk_bf16_f32 v154, v122, v123
    v_cvt_pk_bf16_f32 v155, v124, v125
    ds_write2st64_b32 v25, v154, v155 offset0:10 offset1:11
    v_cvt_pk_bf16_f32 v156, v126, v127
    v_pk_mul_f32 v[110:111], v[92:93], v[86:87] op_sel_hi:[1,0]
    v_pk_mul_f32 v[112:113], v[92:93], v[88:89] op_sel_hi:[1,0]
    v_pk_mul_f32 v[114:115], v[92:93], v[90:91] op_sel_hi:[1,0]
    v_pk_mul_f32 v[116:117], v[94:95], v[80:81] op_sel_hi:[1,0]
    v_pk_fma_f32 v[120:121], v[92:93], v[86:87], v[110:111] op_sel:[1,1,0] op_sel_hi:[0,1,1] neg_lo:[1,0,0]
    v_pk_fma_f32 v[122:123], v[92:93], v[88:89], v[112:113] op_sel:[1,1,0] op_sel_hi:[0,1,1] neg_lo:[1,0,0]
    v_pk_fma_f32 v[124:125], v[92:93], v[90:91], v[114:115] op_sel:[1,1,0] op_sel_hi:[0,1,1] neg_lo:[1,0,0]
    v_pk_fma_f32 v[126:127], v[94:95], v[80:81], v[116:117] op_sel:[1,1,0] op_sel_hi:[0,1,1] neg_lo:[1,0,0]
    v_cvt_pk_bf16_f32 v157, v120, v121
    ds_write2st64_b32 v26, v156, v157 offset0:12 offset1:13
    v_cvt_pk_bf16_f32 v158, v122, v123
    v_cvt_pk_bf16_f32 v159, v124, v125
    ds_write2st64_b32 v27, v158, v159 offset0:14 offset1:15
    v_cvt_pk_bf16_f32 v161, v126, v127
    v_pk_mul_f32 v[110:111], v[94:95], v[84:85] op_sel_hi:[1,0]
    v_pk_mul_f32 v[112:113], v[94:95], v[88:89] op_sel_hi:[1,0]
    v_pk_mul_f32 v[114:115], v[96:97], v[80:81] op_sel_hi:[1,0]
    v_pk_mul_f32 v[116:117], v[96:97], v[84:85] op_sel_hi:[1,0]
    v_pk_fma_f32 v[120:121], v[94:95], v[84:85], v[110:111] op_sel:[1,1,0] op_sel_hi:[0,1,1] neg_lo:[1,0,0]
    v_pk_fma_f32 v[122:123], v[94:95], v[88:89], v[112:113] op_sel:[1,1,0] op_sel_hi:[0,1,1] neg_lo:[1,0,0]
    v_pk_fma_f32 v[124:125], v[96:97], v[80:81], v[114:115] op_sel:[1,1,0] op_sel_hi:[0,1,1] neg_lo:[1,0,0]
    v_pk_fma_f32 v[126:127], v[96:97], v[84:85], v[116:117] op_sel:[1,1,0] op_sel_hi:[0,1,1] neg_lo:[1,0,0]
    ds_read_b128 v[208:211], v28
    ds_read_b128 v[212:215], v29
    ds_read_b128 v[216:219], v30
    ds_read_b128 v[220:223], v31
    ds_write2st64_b32 v20, v160, v161 offset0:0 offset1:1
    v_cvt_pk_bf16_f32 v162, v120, v121
    v_cvt_pk_bf16_f32 v163, v122, v123
    ds_write2st64_b32 v21, v162, v163 offset0:2 offset1:3
    v_cvt_pk_bf16_f32 v165, v124, v125
    ds_write2st64_b32 v22, v164, v165 offset0:4 offset1:5
    v_cvt_pk_bf16_f32 v166, v126, v127
    v_pk_mul_f32 v[110:111], v[96:97], v[88:89] op_sel_hi:[1,0]
    v_pk_mul_f32 v[112:113], v[98:99], v[84:85] op_sel_hi:[1,0]
    v_pk_mul_f32 v[114:115], v[100:101], v[84:85] op_sel_hi:[1,0]
    v_pk_mul_f32 v[116:117], v[102:103], v[84:85] op_sel_hi:[1,0]
    v_pk_fma_f32 v[120:121], v[96:97], v[88:89], v[110:111] op_sel:[1,1,0] op_sel_hi:[0,1,1] neg_lo:[1,0,0]
    v_pk_fma_f32 v[122:123], v[98:99], v[84:85], v[112:113] op_sel:[1,1,0] op_sel_hi:[0,1,1] neg_lo:[1,0,0]
    v_pk_fma_f32 v[124:125], v[100:101], v[84:85], v[114:115] op_sel:[1,1,0] op_sel_hi:[0,1,1] neg_lo:[1,0,0]
    v_pk_fma_f32 v[126:127], v[102:103], v[84:85], v[116:117] op_sel:[1,1,0] op_sel_hi:[0,1,1] neg_lo:[1,0,0]
    v_cvt_pk_bf16_f32 v167, v120, v121
    ds_write2st64_b32 v23, v166, v167 offset0:6 offset1:7
    v_cvt_pk_bf16_f32 v169, v122, v123
    ds_write2st64_b32 v24, v168, v169 offset0:8 offset1:9
    v_cvt_pk_bf16_f32 v171, v124, v125
    ds_write2st64_b32 v25, v170, v171 offset0:10 offset1:11
    v_cvt_pk_bf16_f32 v173, v126, v127
    v_pk_mul_f32 v[110:111], v[104:105], v[84:85] op_sel_hi:[1,0]
    v_pk_mul_f32 v[112:113], v[66:67], v[92:93] op_sel_hi:[1,0]
    v_pk_mul_f32 v[114:115], v[66:67], v[94:95] op_sel_hi:[1,0]
    v_pk_mul_f32 v[116:117], v[66:67], v[96:97] op_sel_hi:[1,0]
    v_pk_fma_f32 v[120:121], v[104:105], v[84:85], v[110:111] op_sel:[1,1,0] op_sel_hi:[0,1,1] neg_lo:[1,0,0]
    v_pk_fma_f32 v[122:123], v[66:67], v[92:93], v[112:113] op_sel:[1,1,0] op_sel_hi:[0,1,1] neg_lo:[1,0,0]
    v_pk_fma_f32 v[124:125], v[66:67], v[94:95], v[114:115] op_sel:[1,1,0] op_sel_hi:[0,1,1] neg_lo:[1,0,0]
    v_pk_fma_f32 v[126:127], v[66:67], v[96:97], v[116:117] op_sel:[1,1,0] op_sel_hi:[0,1,1] neg_lo:[1,0,0]
    ds_write2st64_b32 v26, v172, v173 offset0:12 offset1:13
    v_cvt_pk_bf16_f32 v175, v120, v121
    ds_write2st64_b32 v27, v174, v175 offset0:14 offset1:15
    v_cvt_pk_bf16_f32 v177, v122, v123
    ds_read_b128 v[224:227], v28
    ds_read_b128 v[228:231], v29
    ds_read_b128 v[232:235], v30
    ds_read_b128 v[236:239], v31
    ds_write2st64_b32 v20, v176, v177 offset0:0 offset1:1
    v_cvt_pk_bf16_f32 v178, v124, v125
    v_cvt_pk_bf16_f32 v179, v126, v127
    v_pk_mul_f32 v[110:111], v[66:67], v[98:99] op_sel_hi:[1,0]
    v_pk_mul_f32 v[112:113], v[66:67], v[100:101] op_sel_hi:[1,0]
    v_pk_mul_f32 v[114:115], v[66:67], v[102:103] op_sel_hi:[1,0]
    v_pk_mul_f32 v[116:117], v[66:67], v[104:105] op_sel_hi:[1,0]
    v_pk_fma_f32 v[120:121], v[66:67], v[98:99], v[110:111] op_sel:[1,1,0] op_sel_hi:[0,1,1] neg_lo:[1,0,0]
    v_pk_fma_f32 v[122:123], v[66:67], v[100:101], v[112:113] op_sel:[1,1,0] op_sel_hi:[0,1,1] neg_lo:[1,0,0]
    v_pk_fma_f32 v[124:125], v[66:67], v[102:103], v[114:115] op_sel:[1,1,0] op_sel_hi:[0,1,1] neg_lo:[1,0,0]
    v_pk_fma_f32 v[126:127], v[66:67], v[104:105], v[116:117] op_sel:[1,1,0] op_sel_hi:[0,1,1] neg_lo:[1,0,0]
    ds_write2st64_b32 v21, v178, v179 offset0:2 offset1:3
    v_cvt_pk_bf16_f32 v180, v120, v121
    v_cvt_pk_bf16_f32 v181, v122, v123
    ds_write2st64_b32 v22, v180, v181 offset0:4 offset1:5
    v_cvt_pk_bf16_f32 v182, v124, v125
    v_cvt_pk_bf16_f32 v183, v126, v127
    v_pk_mul_f32 v[110:111], v[66:67], v[66:67] op_sel_hi:[1,0]
    v_pk_fma_f32 v[120:121], v[66:67], v[66:67], v[110:111] op_sel:[1,1,0] op_sel_hi:[0,1,1] neg_lo:[1,0,0]
    ds_write2st64_b32 v23, v182, v183 offset0:6 offset1:7
    v_cvt_pk_bf16_f32 v184, v120, v121
    ds_write_b32 v24, v184 offset:2048
    ds_read_b128 v[240:243], v28
    ds_read_b128 v[244:247], v29
    ds_read_b128 v[248:251], v30
    ds_read_b128 v[252:255], v31
    s_waitcnt lgkmcnt(0)
    v_mfma_f32_16x16x32_bf16 v[128:131], v[208:211], v[192:195], 0
    v_mfma_f32_16x16x32_bf16 v[132:135], v[224:227], v[192:195], 0
    v_mfma_f32_16x16x32_bf16 v[136:139], v[240:243], v[192:195], 0
    v_mfma_f32_16x16x32_bf16 v[128:131], v[212:215], v[196:199], v[128:131]
    v_mfma_f32_16x16x32_bf16 v[132:135], v[228:231], v[196:199], v[132:135]
    v_mfma_f32_16x16x32_bf16 v[136:139], v[244:247], v[196:199], v[136:139]
    v_mfma_f32_16x16x32_bf16 v[128:131], v[216:219], v[200:203], v[128:131]
    v_mfma_f32_16x16x32_bf16 v[132:135], v[232:235], v[200:203], v[132:135]
    v_mfma_f32_16x16x32_bf16 v[136:139], v[248:251], v[200:203], v[136:139]
    v_mfma_f32_16x16x32_bf16 v[128:131], v[220:223], v[204:207], v[128:131]
    v_mfma_f32_16x16x32_bf16 v[132:135], v[236:239], v[204:207], v[132:135]
    v_mfma_f32_16x16x32_bf16 v[136:139], v[252:255], v[204:207], v[136:139]
    s_mul_i32 s40, s5, 3072
    s_add_u32 s40, s40, 155648
    v_lshl_add_u32 v2, v1, 4, s40
    s_lshl_b32 s41, s5, 2
    v_add_u32 v3, s41, v6
    s_bitcmp1_b32 s56, 0
    s_cbranch_scc0 F_kr_55
    s_nop 1
    ds_write_b128 v2, v[128:131] offset:0
    ds_write_b128 v2, v[132:135] offset:1024
    ds_write_b128 v2, v[136:139] offset:2048
    ds_write_b32 v3, v7 offset:16
    s_branch F_kd_56
F_kr_55:
    s_mov_b32 s58, 2097152
F_lw_57:
    ds_read_b32 v4, v3 offset:16
    s_waitcnt lgkmcnt(0)
    v_readfirstlane_b32 s40, v4
    s_cmp_ge_u32 s40, 1
    s_cbranch_scc1 F_lwd_58
    s_sleep 1
    s_sub_u32 s58, s58, 1
    s_cmp_lg_u32 s58, 0
    s_cbranch_scc1 F_lw_57
F_lwd_58:
    ds_read_b128 v[140:143], v2 offset:0
    ds_read_b128 v[144:147], v2 offset:1024
    ds_read_b128 v[148:151], v2 offset:2048
    s_waitcnt lgkmcnt(0)
    v_add_f32 v128, v128, v140
    v_add_f32 v129, v129, v141
    v_add_f32 v130, v130, v142
    v_add_f32 v131, v131, v143
    v_add_f32 v132, v132, v144
    v_add_f32 v133, v133, v145
    v_add_f32 v134, v134, v146
    v_add_f32 v135, v135, v147
    v_add_f32 v136, v136, v148
    v_add_f32 v137, v137, v149
    v_add_f32 v138, v138, v150
    v_add_f32 v139, v139, v151
    v_cvt_pk_bf16_f32 v140, v128, v129
    v_cvt_pk_bf16_f32 v141, v130, v131
    v_cvt_pk_bf16_f32 v142, v132, v133
    v_cvt_pk_bf16_f32 v143, v134, v135
    v_cvt_pk_bf16_f32 v144, v136, v137
    v_cvt_pk_bf16_f32 v145, v138, v139
    ds_write_b64 v32, v[140:141]
    ds_write_b32 v33, v142 offset:512
    ds_write_b32 v34, v143 offset:512
    ds_write_b16 v35, v144 offset:1024
    ds_write_b16_d16_hi v35, v144 offset:1056
    ds_write_b16 v35, v145 offset:1088
    ds_write_b16_d16_hi v35, v145 offset:1120
F_kd_56:
    s_mov_b64 exec, 1
    ds_add_u32 v6, v7 offset:28
    s_mov_b64 exec, -1
    s_mov_b32 s58, 2097152
F_lw_59:
    ds_read_b32 v2, v6 offset:28
    s_waitcnt lgkmcnt(0)
    v_readfirstlane_b32 s40, v2
    s_cmp_ge_u32 s40, 4
    s_cbranch_scc1 F_lwd_60
    s_sleep 1
    s_sub_u32 s58, s58, 1
    s_cmp_lg_u32 s58, 0
    s_cbranch_scc1 F_lw_59
F_lwd_60:
    ds_read_u16 v56, v38 offset:0
    ds_read_u16 v57, v39 offset:0
    ds_read_u16 v58, v40 offset:0
    ds_read_u16 v59, v41 offset:0
    ds_read_u16 v60, v42 offset:0
    ds_read_u16 v61, v43 offset:0
    ds_read_u16 v62, v44 offset:0
    ds_read_u16 v63, v45 offset:0
    ds_read_u16 v64, v46 offset:0
    ds_read_u16 v65, v47 offset:0
    ds_read_u16 v66, v48 offset:0
    ds_read_u16 v67, v38 offset:3072
    ds_read_u16 v68, v39 offset:3072
    ds_read_u16 v69, v40 offset:3072
    ds_read_u16 v70, v41 offset:3072
    ds_read_u16 v71, v42 offset:3072
    ds_read_u16 v72, v43 offset:3072
    ds_read_u16 v73, v44 offset:3072
    ds_read_u16 v74, v45 offset:3072
    ds_read_u16 v75, v46 offset:3072
    ds_read_u16 v76, v47 offset:3072
    ds_read_u16 v77, v48 offset:3072
    s_waitcnt lgkmcnt(0)
    v_lshl_or_b32 v128, v60, 16, v59
    v_lshl_or_b32 v129, v62, 16, v61
    v_lshl_or_b32 v130, v64, 16, v63
    v_lshl_or_b32 v131, v66, 16, v65
    v_lshl_or_b32 v132, v59, 16, v58
    v_lshl_or_b32 v133, v61, 16, v60
    v_lshl_or_b32 v134, v63, 16, v62
    v_lshl_or_b32 v135, v65, 16, v64
    v_lshl_or_b32 v136, v58, 16, v57
    v_lshl_or_b32 v137, v60, 16, v59
    v_lshl_or_b32 v138, v62, 16, v61
    v_lshl_or_b32 v139, v64, 16, v63
    v_lshl_or_b32 v140, v57, 16, v56
    v_lshl_or_b32 v141, v59, 16, v58
    v_lshl_or_b32 v142, v61, 16, v60
    v_lshl_or_b32 v143, v63, 16, v62
    v_lshl_or_b32 v144, v71, 16, v70
    v_lshl_or_b32 v145, v73, 16, v72
    v_lshl_or_b32 v146, v75, 16, v74
    v_lshl_or_b32 v147, v77, 16, v76
    v_lshl_or_b32 v148, v70, 16, v69
    v_lshl_or_b32 v149, v72, 16, v71
    v_lshl_or_b32 v150, v74, 16, v73
    v_lshl_or_b32 v151, v76, 16, v75
    v_lshl_or_b32 v152, v69, 16, v68
    v_lshl_or_b32 v153, v71, 16, v70
    v_lshl_or_b32 v154, v73, 16, v72
    v_lshl_or_b32 v155, v75, 16, v74
    v_lshl_or_b32 v156, v68, 16, v67
    v_lshl_or_b32 v157, v70, 16, v69
    v_lshl_or_b32 v158, v72, 16, v71
    v_lshl_or_b32 v159, v74, 16, v73
    v_add_u32 v78, 114688, v54
    v_lshrrev_b32 v80, 3, v1
    v_and_b32 v81, 3, v80
    v_and_b32 v82, 7, v1
    v_lshlrev_b32 v82, 1, v82
    v_sub_u32 v83, v81, v82
    v_lshrrev_b32 v84, 5, v1
    v_mul_u32_u24 v84, 3072, v84
    v_max_i32 v85, 1, v83
    v_lshl_add_u32 v84, v85, 1, v84
    v_add_u32 v84, 155646, v84
    ds_read_u16 v86, v84 offset:2
    ds_read_u16 v87, v84
    v_mul_u32_u24 v80, 4160, v80
    v_lshl_add_u32 v80, v82, 1, v80
    v_add_u32 v161, 118784, v80
    v_cmp_eq_u32 vcc, 0, v83
    v_cmp_lt_i32 s[40:41], 0, v83
    s_waitcnt lgkmcnt(0)
    v_lshl_or_b32 v86, v87, 16, v86
    v_cndmask_b32 v87, 0, v87, vcc
    v_cndmask_b32 v160, v87, v86, s[40:41]
    v_mov_b64 v[164:165], 0
    v_mov_b64 v[166:167], 0
    v_lshrrev_b32 v84, 5, v1
    v_mul_u32_u24 v84, 4608, v84
    v_and_b32 v85, 31, v1
    v_min_u32 v85, 29, v85
    v_lshl_add_u32 v84, v85, 4, v84
    v_add_u32 v162, 147968, v84
    ds_write_b128 v78, v[128:131] offset:0
    ds_write_b128 v78, v[132:135] offset:4160
    ds_write_b128 v78, v[136:139] offset:8320
    ds_write_b128 v78, v[140:143] offset:12480
    ds_write_b128 v78, v[144:147] offset:16640
    ds_write_b128 v78, v[148:151] offset:20800
    ds_write_b128 v78, v[152:155] offset:24960
    ds_write_b128 v78, v[156:159] offset:29120
    s_mov_b64 exec, 1
    ds_add_u32 v6, v7 offset:28
    s_mov_b64 exec, -1
    s_waitcnt vmcnt(0)
    v_cmp_eq_u32 vcc, 0, v36
    s_cbranch_vccz F_tagok_61
    s_mov_b64 exec, -1
    s_mov_b32 s58, 2097152
F_poll_62:
    buffer_load_dword v36, v14, s[32:35], 0 offen sc1
    s_waitcnt vmcnt(0)
    v_cmp_eq_u32 vcc, 0, v36
    s_cbranch_vccz F_polld_63
    s_sleep 3
    s_sub_u32 s58, s58, 1
    s_cmp_lg_u32 s58, 0
    s_cbranch_scc1 F_poll_62
F_polld_63:
    s_mov_b64 exec, -1
F_tagok_61:
    v_readfirstlane_b32 s62, v36
    s_nop 1
    v_mov_b32 v2, s62
    ds_write_b32 v6, v2 offset:8
    s_mov_b32 s58, 2097152
F_lw_64:
    ds_read_b32 v2, v6 offset:28
    s_waitcnt lgkmcnt(0)
    v_readfirstlane_b32 s40, v2
    s_cmp_ge_u32 s40, 8
    s_cbranch_scc1 F_lwd_65
    s_sleep 1
    s_sub_u32 s58, s58, 1
    s_cmp_lg_u32 s58, 0
    s_cbranch_scc1 F_lw_64
F_lwd_65:
    s_lshr_b32 s41, s2, 6
    s_lshl_b32 s41, s41, 7
    s_add_u32 s41, s41, 7393280
    s_mov_b64 exec, -1
    s_mov_b32 s58, 2097152
F_poll_66:
    buffer_load_dword v37, v14, s[8:11], s41 offen sc1
    s_waitcnt vmcnt(0)
    v_cmp_ne_u32 vcc, v36, v37
    s_cbranch_vccz F_polld_67
    s_sleep 3
    s_sub_u32 s58, s58, 1
    s_cmp_lg_u32 s58, 0
    s_cbranch_scc1 F_poll_66
F_polld_67:
    s_mov_b64 exec, -1
    s_lshl_b32 s36, s2, 8
    s_add_u32 s36, s36, 7864320
    s_add_u32 s37, s36, 1052672
    buffer_load_dwordx4 v[188:191], v55, s[8:11], s36 offen sc1
    buffer_load_dwordx4 v[192:195], v55, s[8:11], s37 offen sc1
    s_lshr_b32 s91, s2, 5
    s_mul_i32 s91, s91, 8448
    s_and_b32 s41, s2, 31
    s_lshl_b32 s41, s41, 1
    s_add_u32 s41, s41, s5
    s_lshl_b32 s41, s41, 7
    s_add_u32 s91, s91, s41
    s_add_u32 s91, s91, 10485760
    s_lshl_b32 s41, s5, 4
    s_lshr_b32 s38, s63, s41
    s_and_b32 s38, s38, 0xffff
    s_and_b32 s41, s56, 1
    s_sub_u32 s41, s41, 1
    s_and_b32 s38, s38, s41
    v_and_b32 v2, 15, v1
    v_lshrrev_b32 v3, 4, v1
    v_lshlrev_b32 v3, 3, v3
    v_sub_u32 v2, v2, v3
    v_add_u32 v2, 16, v2
    v_ashrrev_i32 v2, 1, v2
    v_and_b32 v3, 1, v1
    v_lshlrev_b32 v3, 4, v3
    v_lshlrev_b32 v3, v3, s38
    v_cmp_eq_i32 s[78:79], 0, v2
    v_cmp_eq_i32 s[80:81], 1, v2
    v_cmp_eq_i32 s[82:83], 2, v2
    v_cmp_eq_i32 s[84:85], 3, v2
    v_cndmask_b32 v16, 0, v3, s[78:79]
    v_cndmask_b32 v17, 0, v3, s[80:81]
    v_cndmask_b32 v18, 0, v3, s[82:83]
    v_cndmask_b32 v19, 0, v3, s[84:85]
    s_and_b32 s41, s56, 1
    s_lshl_b32 s41, s41, 5
    s_lshr_b32 s57, s2, 3
    s_add_u32 s57, s57, s41
    s_mul_i32 s57, s57, 1280
    s_and_b32 s41, s2, 7
    s_lshl_b32 s41, s41, 1
    s_add_u32 s41, s41, s5
    s_lshl_b32 s41, s41, 2
    s_add_u32 s57, s57, s41
    s_add_u32 s57, s57, 7471104
    s_waitcnt vmcnt(0)
    s_mov_b32 s55, 2
    s_branch F_pp
F_last:
    s_endpgm

.section .rodata,"a"
.p2align 6
.amdhsa_kernel parallel_sum__ssm_conv_s4d__glu_gated_bilinear__prompt_kernel
  .amdhsa_next_free_vgpr 256
  .amdhsa_next_free_sgpr 102
  .amdhsa_accum_offset 256
  .amdhsa_group_segment_fixed_size 0
  .amdhsa_kernarg_size 112
  .amdhsa_user_sgpr_count 2
  .amdhsa_user_sgpr_kernarg_segment_ptr 1
  .amdhsa_system_sgpr_workgroup_id_x 1
.end_amdhsa_kernel
```
